```python
import torch

def _softmax(x, axis=-1):
    return torch.softmax(x, dim=axis)
def _gelu(x):
    return torch.nn.functional.gelu(x, approximate="tanh")
def _silu(x):
    return torch.nn.functional.silu(x)
def _sigmoid(x):
    return torch.sigmoid(x)
def _layernorm(x, axis=-1, eps=1e-5):
    m = x.mean(dim=axis, keepdim=True)
    v = x.var(dim=axis, keepdim=True, unbiased=False)
    return (x - m) / torch.sqrt(v + eps)
def _scatter_add(tgt, idx, src, axis=0):
    return tgt.clone().index_add_(axis, idx, src)
def _segment_sum(src, seg, n):
    out = torch.zeros((n,) + src.shape[1:], dtype=src.dtype)
    return out.index_add_(0, seg, src)
def _pad(x, pw):
    flat = tuple(v for pair in reversed(pw) for v in pair)
    return torch.nn.functional.pad(x, flat)

kernel_name = 'standalone__swiglu_ffn__prompt'

def setup_inputs():

    _w = (lambda a: (lambda t: t.to(torch.bfloat16) if t.is_floating_point() else t)(torch.as_tensor(a)))
    B, S, D, F = 1, 2048, 512, 1376
    return {
        "x": _w((lambda *s: torch.randn(*s, dtype=torch.bfloat16) * 0.05)(B, S, D)),
        "w_gate": _w((lambda *s: torch.randn(*s, dtype=torch.bfloat16) * 0.05)(D, F)),
        "w_up": _w((lambda *s: torch.randn(*s, dtype=torch.bfloat16) * 0.05)(D, F)),
        "w_down": _w((lambda *s: torch.randn(*s, dtype=torch.bfloat16) * 0.05)(F, D)),
    }

def reference(x, w_gate, w_up, w_down):
    g = _silu(x @ w_gate)
    u = x @ w_up
    return (g * u) @ w_down
```

```asm
; @launch grid=(256,1,1) block=(768,1,1) lds=163840
.amdgcn_target "amdgcn-amd-amdhsa--gfx950"
.text
.globl standalone__swiglu_ffn__prompt_kernel
.p2align 8
.type standalone__swiglu_ffn__prompt_kernel,@function
standalone__swiglu_ffn__prompt_kernel:
  s_cmp_ge_u32 s2, 256
  s_cbranch_scc1 L_done
  s_load_dwordx8 s[4:11], s[0:1], 0
  s_load_dwordx4 s[12:15], s[0:1], 32
  s_load_dwordx2 s[16:17], s[0:1], 48
  s_and_b32 s50, s2, 7
  s_lshr_b32 s51, s2, 3
  s_and_b32 s45, s50, 1
  s_lshl_b32 s45, s45, 3
  s_and_b32 s52, s51, 7
  s_add_u32 s45, s45, s52
  s_lshr_b32 s46, s50, 1
  s_lshl_b32 s46, s46, 2
  s_lshr_b32 s52, s51, 3
  s_add_u32 s46, s46, s52
  s_lshl_b32 s47, s50, 2
  s_and_b32 s52, s51, 3
  s_add_u32 s47, s47, s52
  s_lshr_b32 s48, s51, 2
  s_lshl_b32 s49, s48, 7
  v_lshrrev_b32 v1, 6, v0
  v_and_b32 v2, 63, v0
  v_readfirstlane_b32 s44, v1
  v_lshrrev_b32 v3, 3, v2
  v_lshrrev_b32 v4, 4, v2
  v_and_b32 v5, 7, v2
  s_cmp_lt_u32 s44, 8
  s_cbranch_scc1 L_compute
  s_sub_u32 s68, s44, 8
  s_lshl_b32 s52, s2, 2
  s_add_u32 s52, s52, s68
  s_mul_i32 s52, s52, 1408
  v_lshlrev_b32 v9, 7, v2
  v_add_u32 v9, s52, v9
  v_cmp_gt_u32 vcc, 11, v2
  v_mov_b32 v8, 0x40000000
  s_lshl_b32 s52, s45, 7
  s_lshl_b32 s53, s68, 5
  v_cndmask_b32 v9, v8, v9, vcc
  s_add_u32 s52, s52, s53
  v_add_u32 v6, s52, v3
  v_lshlrev_b32 v6, 10, v6
  v_xor_b32 v7, v5, v4
  v_lshl_add_u32 v10, v7, 4, v6
  v_xor_b32 v7, 4, v7
  v_lshl_add_u32 v11, v7, 4, v6
  v_add_u32 v12, 14336, v10
  v_add_u32 v13, 21504, v11
  v_add_u32 v11, 7168, v11
  v_lshlrev_b32 v7, 1, v4
  v_xor_b32 v14, v7, v5
  s_mul_i32 s54, s46, 192
  v_and_b32 v6, 3, v3
  v_and_b32 v7, 4, v3
  v_lshl_add_u32 v6, v7, 1, v6
  v_mul_u32_u24 v6, 2752, v6
  v_add_u32 v6, s54, v6
  s_and_b32 s53, s68, 1
  s_mul_i32 s53, s53, 88064
  v_lshl_add_u32 v7, v14, 4, v6
  v_add_u32 v7, s53, v7
  v_add_u32 v16, 0, v7
  v_add_u32 v17, 9984, v7
  v_add_u32 v18, 41984, v7
  v_add_u32 v19, 51968, v7
  v_and_b32 v7, 3, v14
  v_lshl_add_u32 v7, v7, 4, v6
  s_mul_i32 s53, s68, 44032
  s_add_u32 s53, s53, 128
  v_add_u32 v20, s53, v7
  v_add_u32 v21, 9984, v20
  v_cmp_gt_u32 s[64:65], 4, v14
  s_and_b32 s55, s46, 3
  s_lshl_b32 s55, s55, 1
  s_and_b32 s52, s45, 7
  s_add_u32 s55, s55, s52
  s_sub_u32 s52, s55, 7
  s_cmp_ge_u32 s55, 7
  s_cselect_b32 s55, s52, s55
  s_mov_b32 s3, s55
  s_lshl_b32 s56, s68, 12
  s_add_u32 s57, s56, 16384
  s_lshl_b32 s69, s68, 11
  s_not_b64 s[66:67], s[64:65]
  s_waitcnt lgkmcnt(0)
  s_mov_b32 s20, s4
  s_and_b32 s21, s5, 0xffff
  s_mov_b32 s22, 2097152
  s_mov_b32 s23, 0x20000
  s_cmp_lt_u32 s68, 2
  s_cselect_b32 s24, s6, s8
  s_cselect_b32 s25, s7, s9
  s_and_b32 s25, s25, 0xffff
  s_mov_b32 s26, 1409024
  s_mov_b32 s27, 0x20000
  s_mov_b32 s28, s10
  s_and_b32 s29, s11, 0xffff
  s_mov_b32 s30, 1409024
  s_mov_b32 s31, 0x20000
  s_cmp_ge_u32 s46, 15
  s_cbranch_scc1 L_skip_issue0
  s_add_u32 m0, s56, 0
  s_nop 0
  buffer_load_dwordx4 v10, s[20:23], 0 offen offset:0 lds
  buffer_load_dwordx4 v11, s[20:23], 0 offen offset:1024 lds
  buffer_load_dwordx4 v12, s[20:23], 0 offen offset:2048 lds
  buffer_load_dwordx4 v13, s[20:23], 0 offen offset:3072 lds
  s_add_u32 m0, s57, 0
  s_nop 0
  buffer_load_dwordx4 v16, s[24:27], 0 offen offset:0 lds
  buffer_load_dwordx4 v17, s[24:27], 0 offen offset:1024 lds
  buffer_load_dwordx4 v18, s[24:27], 0 offen offset:2048 lds
  buffer_load_dwordx4 v19, s[24:27], 0 offen offset:3072 lds
  s_lshl_b32 s58, s55, 7
  s_add_u32 s58, s58, 128
  s_mul_i32 s59, s55, 176128
  s_add_u32 s59, s59, 176128
  s_add_u32 s55, s55, 1
  s_cmp_eq_u32 s55, 7
  s_cselect_b32 s55, 0, s55
  s_add_u32 m0, s56, 32768
  s_nop 0
  buffer_load_dwordx4 v10, s[20:23], s58 offen offset:0 lds
  buffer_load_dwordx4 v11, s[20:23], s58 offen offset:1024 lds
  buffer_load_dwordx4 v12, s[20:23], s58 offen offset:2048 lds
  buffer_load_dwordx4 v13, s[20:23], s58 offen offset:3072 lds
  s_add_u32 m0, s57, 32768
  s_nop 0
  buffer_load_dwordx4 v16, s[24:27], s59 offen offset:0 lds
  buffer_load_dwordx4 v17, s[24:27], s59 offen offset:1024 lds
  buffer_load_dwordx4 v18, s[24:27], s59 offen offset:2048 lds
  buffer_load_dwordx4 v19, s[24:27], s59 offen offset:3072 lds
  s_lshl_b32 s58, s55, 7
  s_add_u32 s58, s58, 128
  s_mul_i32 s59, s55, 176128
  s_add_u32 s59, s59, 176128
  s_add_u32 s55, s55, 1
  s_cmp_eq_u32 s55, 7
  s_cselect_b32 s55, 0, s55
  s_add_u32 m0, s56, 65536
  s_nop 0
  buffer_load_dwordx4 v10, s[20:23], s58 offen offset:0 lds
  buffer_load_dwordx4 v11, s[20:23], s58 offen offset:1024 lds
  buffer_load_dwordx4 v12, s[20:23], s58 offen offset:2048 lds
  buffer_load_dwordx4 v13, s[20:23], s58 offen offset:3072 lds
  s_add_u32 m0, s57, 65536
  s_nop 0
  buffer_load_dwordx4 v16, s[24:27], s59 offen offset:0 lds
  buffer_load_dwordx4 v17, s[24:27], s59 offen offset:1024 lds
  buffer_load_dwordx4 v18, s[24:27], s59 offen offset:2048 lds
  buffer_load_dwordx4 v19, s[24:27], s59 offen offset:3072 lds
L_skip_issue0:
  buffer_load_dword v31, v9, s[28:31], 0 offen
  s_mov_b32 s32, s16
  s_and_b32 s33, s17, 0xffff
  s_mov_b32 s34, 8388608
  s_mov_b32 s35, 0x20000
  s_mov_b32 s40, s14
  s_and_b32 s41, s15, 0xffff
  s_mov_b32 s42, 256
  s_mov_b32 s43, 0x20000
  s_mov_b32 s36, s6
  s_and_b32 s37, s7, 0xffff
  s_mov_b32 s38, 1409024
  s_mov_b32 s39, 0x20000
  s_mov_b32 s60, s8
  s_and_b32 s61, s9, 0xffff
  s_mov_b32 s62, 1409024
  s_mov_b32 s63, 0x20000
  s_add_u32 s52, s68, s2
  v_mov_b32 v1, 0
  s_cmp_lg_u32 s52, 0
  s_cbranch_scc1 L_notok
  s_memrealtime s[52:53]
  s_waitcnt lgkmcnt(0)
  s_or_b32 s52, s52, 1
  v_mov_b32 v8, s52
  s_mov_b64 exec, 1
  buffer_store_dword v8, v1, s[40:43], 0 offen sc1
  s_mov_b64 exec, -1
L_notok:
  v_lshlrev_b32 v6, 10, v3
  v_lshl_add_u32 v6, v14, 4, v6
  v_add_u32 v15, s49, v6
  s_cmp_ge_u32 s46, 15
  s_cbranch_scc1 L_idle_l
  s_waitcnt vmcnt(17)
  s_barrier
  s_waitcnt vmcnt(9)
  s_barrier
  s_lshl_b32 s58, s55, 7
  s_add_u32 s58, s58, 128
  s_mul_i32 s59, s55, 176128
  s_add_u32 s59, s59, 176128
  s_add_u32 s55, s55, 1
  s_cmp_eq_u32 s55, 7
  s_cselect_b32 s55, 0, s55
  s_add_u32 m0, s56, 98304
  s_nop 0
  buffer_load_dwordx4 v10, s[20:23], s58 offen offset:0 lds
  buffer_load_dwordx4 v11, s[20:23], s58 offen offset:1024 lds
  buffer_load_dwordx4 v12, s[20:23], s58 offen offset:2048 lds
  buffer_load_dwordx4 v13, s[20:23], s58 offen offset:3072 lds
  s_add_u32 m0, s57, 98304
  s_nop 0
  buffer_load_dwordx4 v16, s[24:27], s59 offen offset:0 lds
  buffer_load_dwordx4 v17, s[24:27], s59 offen offset:1024 lds
  buffer_load_dwordx4 v18, s[24:27], s59 offen offset:2048 lds
  buffer_load_dwordx4 v19, s[24:27], s59 offen offset:3072 lds
  s_waitcnt vmcnt(9)
  s_barrier
  s_lshl_b32 s58, s55, 7
  s_add_u32 s58, s58, 128
  s_mul_i32 s59, s55, 176128
  s_add_u32 s59, s59, 176128
  s_add_u32 s55, s55, 1
  s_cmp_eq_u32 s55, 7
  s_cselect_b32 s55, 0, s55
  s_add_u32 m0, s56, 0
  s_nop 0
  buffer_load_dwordx4 v10, s[20:23], s58 offen offset:0 lds
  buffer_load_dwordx4 v11, s[20:23], s58 offen offset:1024 lds
  buffer_load_dwordx4 v12, s[20:23], s58 offen offset:2048 lds
  buffer_load_dwordx4 v13, s[20:23], s58 offen offset:3072 lds
  s_add_u32 m0, s57, 0
  s_nop 0
  buffer_load_dwordx4 v16, s[24:27], s59 offen offset:0 lds
  buffer_load_dwordx4 v17, s[24:27], s59 offen offset:1024 lds
  buffer_load_dwordx4 v18, s[24:27], s59 offen offset:2048 lds
  buffer_load_dwordx4 v19, s[24:27], s59 offen offset:3072 lds
  s_waitcnt vmcnt(8)
  s_barrier
  s_lshl_b32 s58, s55, 7
  s_add_u32 s58, s58, 128
  s_mul_i32 s59, s55, 176128
  s_add_u32 s59, s59, 176128
  s_add_u32 s55, s55, 1
  s_cmp_eq_u32 s55, 7
  s_cselect_b32 s55, 0, s55
  s_add_u32 m0, s56, 32768
  s_nop 0
  buffer_load_dwordx4 v10, s[20:23], s58 offen offset:0 lds
  buffer_load_dwordx4 v11, s[20:23], s58 offen offset:1024 lds
  buffer_load_dwordx4 v12, s[20:23], s58 offen offset:2048 lds
  buffer_load_dwordx4 v13, s[20:23], s58 offen offset:3072 lds
  s_add_u32 m0, s57, 32768
  s_nop 0
  buffer_load_dwordx4 v16, s[24:27], s59 offen offset:0 lds
  buffer_load_dwordx4 v17, s[24:27], s59 offen offset:1024 lds
  buffer_load_dwordx4 v18, s[24:27], s59 offen offset:2048 lds
  buffer_load_dwordx4 v19, s[24:27], s59 offen offset:3072 lds
  s_waitcnt vmcnt(8)
  s_barrier
  s_lshl_b32 s58, s55, 7
  s_add_u32 s58, s58, 128
  s_mul_i32 s59, s55, 176128
  s_add_u32 s59, s59, 176128
  s_add_u32 s55, s55, 1
  s_cmp_eq_u32 s55, 7
  s_cselect_b32 s55, 0, s55
  s_add_u32 m0, s56, 65536
  s_nop 0
  buffer_load_dwordx4 v10, s[20:23], s58 offen offset:0 lds
  buffer_load_dwordx4 v11, s[20:23], s58 offen offset:1024 lds
  buffer_load_dwordx4 v12, s[20:23], s58 offen offset:2048 lds
  buffer_load_dwordx4 v13, s[20:23], s58 offen offset:3072 lds
  s_add_u32 m0, s57, 65536
  s_nop 0
  buffer_load_dwordx4 v16, s[24:27], s59 offen offset:0 lds
  buffer_load_dwordx4 v17, s[24:27], s59 offen offset:1024 lds
  buffer_load_dwordx4 v18, s[24:27], s59 offen offset:2048 lds
  buffer_load_dwordx4 v19, s[24:27], s59 offen offset:3072 lds
  s_waitcnt vmcnt(8)
  s_barrier
  s_lshl_b32 s58, s55, 7
  s_add_u32 s58, s58, 128
  s_mul_i32 s59, s55, 176128
  s_add_u32 s59, s59, 176128
  s_add_u32 s55, s55, 1
  s_cmp_eq_u32 s55, 7
  s_cselect_b32 s55, 0, s55
  s_add_u32 m0, s56, 98304
  s_nop 0
  buffer_load_dwordx4 v10, s[20:23], s58 offen offset:0 lds
  buffer_load_dwordx4 v11, s[20:23], s58 offen offset:1024 lds
  buffer_load_dwordx4 v12, s[20:23], s58 offen offset:2048 lds
  buffer_load_dwordx4 v13, s[20:23], s58 offen offset:3072 lds
  s_add_u32 m0, s57, 98304
  s_nop 0
  buffer_load_dwordx4 v16, s[24:27], s59 offen offset:0 lds
  buffer_load_dwordx4 v17, s[24:27], s59 offen offset:1024 lds
  buffer_load_dwordx4 v18, s[24:27], s59 offen offset:2048 lds
  buffer_load_dwordx4 v19, s[24:27], s59 offen offset:3072 lds
  s_waitcnt vmcnt(8)
  s_barrier
  s_mov_b32 s59, 0
  s_add_u32 m0, s69, 131072
  s_mov_b64 exec, s[64:65]
  buffer_load_dwordx4 v20, s[36:39], s59 offen offset:0 lds
  buffer_load_dwordx4 v21, s[36:39], s59 offen offset:1024 lds
  s_mov_b64 exec, s[66:67]
  buffer_load_dwordx4 v20, s[60:63], s59 offen offset:0 lds
  buffer_load_dwordx4 v21, s[60:63], s59 offen offset:1024 lds
  s_mov_b64 exec, -1
  s_mul_i32 s59, s3, 176128
  s_add_u32 s59, s59, 176128
  s_add_u32 s3, s3, 1
  s_cmp_eq_u32 s3, 7
  s_cselect_b32 s3, 0, s3
  s_add_u32 m0, s69, 139264
  s_mov_b64 exec, s[64:65]
  buffer_load_dwordx4 v20, s[36:39], s59 offen offset:0 lds
  buffer_load_dwordx4 v21, s[36:39], s59 offen offset:1024 lds
  s_mov_b64 exec, s[66:67]
  buffer_load_dwordx4 v20, s[60:63], s59 offen offset:0 lds
  buffer_load_dwordx4 v21, s[60:63], s59 offen offset:1024 lds
  s_mov_b64 exec, -1
  s_mul_i32 s59, s3, 176128
  s_add_u32 s59, s59, 176128
  s_add_u32 s3, s3, 1
  s_cmp_eq_u32 s3, 7
  s_cselect_b32 s3, 0, s3
  s_add_u32 m0, s69, 147456
  s_mov_b64 exec, s[64:65]
  buffer_load_dwordx4 v20, s[36:39], s59 offen offset:0 lds
  buffer_load_dwordx4 v21, s[36:39], s59 offen offset:1024 lds
  s_mov_b64 exec, s[66:67]
  buffer_load_dwordx4 v20, s[60:63], s59 offen offset:0 lds
  buffer_load_dwordx4 v21, s[60:63], s59 offen offset:1024 lds
  s_mov_b64 exec, -1
  s_mul_i32 s59, s3, 176128
  s_add_u32 s59, s59, 176128
  s_add_u32 s3, s3, 1
  s_cmp_eq_u32 s3, 7
  s_cselect_b32 s3, 0, s3
  s_add_u32 m0, s69, 155648
  s_mov_b64 exec, s[64:65]
  buffer_load_dwordx4 v20, s[36:39], s59 offen offset:0 lds
  buffer_load_dwordx4 v21, s[36:39], s59 offen offset:1024 lds
  s_mov_b64 exec, s[66:67]
  buffer_load_dwordx4 v20, s[60:63], s59 offen offset:0 lds
  buffer_load_dwordx4 v21, s[60:63], s59 offen offset:1024 lds
  s_mov_b64 exec, -1
  s_waitcnt vmcnt(16)
  s_barrier
  s_mul_i32 s59, s3, 176128
  s_add_u32 s59, s59, 176128
  s_add_u32 s3, s3, 1
  s_cmp_eq_u32 s3, 7
  s_cselect_b32 s3, 0, s3
  s_add_u32 m0, s69, 0
  s_mov_b64 exec, s[64:65]
  buffer_load_dwordx4 v20, s[36:39], s59 offen offset:0 lds
  buffer_load_dwordx4 v21, s[36:39], s59 offen offset:1024 lds
  s_mov_b64 exec, s[66:67]
  buffer_load_dwordx4 v20, s[60:63], s59 offen offset:0 lds
  buffer_load_dwordx4 v21, s[60:63], s59 offen offset:1024 lds
  s_mov_b64 exec, -1
  s_mul_i32 s59, s3, 176128
  s_add_u32 s59, s59, 176128
  s_add_u32 s3, s3, 1
  s_cmp_eq_u32 s3, 7
  s_cselect_b32 s3, 0, s3
  s_add_u32 m0, s69, 8192
  s_mov_b64 exec, s[64:65]
  buffer_load_dwordx4 v20, s[36:39], s59 offen offset:0 lds
  buffer_load_dwordx4 v21, s[36:39], s59 offen offset:1024 lds
  s_mov_b64 exec, s[66:67]
  buffer_load_dwordx4 v20, s[60:63], s59 offen offset:0 lds
  buffer_load_dwordx4 v21, s[60:63], s59 offen offset:1024 lds
  s_mov_b64 exec, -1
  s_mul_i32 s59, s3, 176128
  s_add_u32 s59, s59, 176128
  s_add_u32 s3, s3, 1
  s_cmp_eq_u32 s3, 7
  s_cselect_b32 s3, 0, s3
  s_add_u32 m0, s69, 16384
  s_mov_b64 exec, s[64:65]
  buffer_load_dwordx4 v20, s[36:39], s59 offen offset:0 lds
  buffer_load_dwordx4 v21, s[36:39], s59 offen offset:1024 lds
  s_mov_b64 exec, s[66:67]
  buffer_load_dwordx4 v20, s[60:63], s59 offen offset:0 lds
  buffer_load_dwordx4 v21, s[60:63], s59 offen offset:1024 lds
  s_mov_b64 exec, -1
  s_mul_i32 s59, s3, 176128
  s_add_u32 s59, s59, 176128
  s_add_u32 s3, s3, 1
  s_cmp_eq_u32 s3, 7
  s_cselect_b32 s3, 0, s3
  s_add_u32 m0, s69, 24576
  s_mov_b64 exec, s[64:65]
  buffer_load_dwordx4 v20, s[36:39], s59 offen offset:0 lds
  buffer_load_dwordx4 v21, s[36:39], s59 offen offset:1024 lds
  s_mov_b64 exec, s[66:67]
  buffer_load_dwordx4 v20, s[60:63], s59 offen offset:0 lds
  buffer_load_dwordx4 v21, s[60:63], s59 offen offset:1024 lds
  s_mov_b64 exec, -1
  s_waitcnt vmcnt(16)
  s_barrier
  s_mul_i32 s52, s68, 2
  s_lshl_b32 s53, s52, 12
  s_add_u32 s53, s53, 32768
  s_add_u32 s52, s52, 0
  s_lshr_b32 s54, s52, 1
  s_mul_i32 s54, s54, 3
  s_and_b32 s58, s52, 1
  s_add_u32 s54, s54, s58
  s_mul_i32 s58, s52, 3
  s_sub_u32 s58, s58, 85
  s_cmp_le_u32 s52, 28
  s_cselect_b32 s54, s54, s58
  s_lshl_b32 s54, s54, 15
  s_mov_b32 m0, s53
  s_add_u32 s58, s54, 0
  buffer_load_dwordx4 v15, s[28:31], s58 offen offset:0 lds
  s_add_u32 s58, s54, 7168
  buffer_load_dwordx4 v15, s[28:31], s58 offen offset:1024 lds
  s_add_u32 s58, s54, 14336
  buffer_load_dwordx4 v15, s[28:31], s58 offen offset:2048 lds
  s_add_u32 s58, s54, 21504
  buffer_load_dwordx4 v15, s[28:31], s58 offen offset:3072 lds
  s_mul_i32 s52, s68, 2
  s_lshl_b32 s53, s52, 12
  s_add_u32 s53, s53, 36864
  s_add_u32 s52, s52, 1
  s_lshr_b32 s54, s52, 1
  s_mul_i32 s54, s54, 3
  s_and_b32 s58, s52, 1
  s_add_u32 s54, s54, s58
  s_mul_i32 s58, s52, 3
  s_sub_u32 s58, s58, 85
  s_cmp_le_u32 s52, 28
  s_cselect_b32 s54, s54, s58
  s_lshl_b32 s54, s54, 15
  s_mov_b32 m0, s53
  s_add_u32 s58, s54, 0
  buffer_load_dwordx4 v15, s[28:31], s58 offen offset:0 lds
  s_add_u32 s58, s54, 7168
  buffer_load_dwordx4 v15, s[28:31], s58 offen offset:1024 lds
  s_add_u32 s58, s54, 14336
  buffer_load_dwordx4 v15, s[28:31], s58 offen offset:2048 lds
  s_add_u32 s58, s54, 21504
  buffer_load_dwordx4 v15, s[28:31], s58 offen offset:3072 lds
  s_mul_i32 s52, s68, 2
  s_lshl_b32 s53, s52, 12
  s_add_u32 s53, s53, 65536
  s_add_u32 s52, s52, 8
  s_lshr_b32 s54, s52, 1
  s_mul_i32 s54, s54, 3
  s_and_b32 s58, s52, 1
  s_add_u32 s54, s54, s58
  s_mul_i32 s58, s52, 3
  s_sub_u32 s58, s58, 85
  s_cmp_le_u32 s52, 28
  s_cselect_b32 s54, s54, s58
  s_lshl_b32 s54, s54, 15
  s_mov_b32 m0, s53
  s_add_u32 s58, s54, 0
  buffer_load_dwordx4 v15, s[28:31], s58 offen offset:0 lds
  s_add_u32 s58, s54, 7168
  buffer_load_dwordx4 v15, s[28:31], s58 offen offset:1024 lds
  s_add_u32 s58, s54, 14336
  buffer_load_dwordx4 v15, s[28:31], s58 offen offset:2048 lds
  s_add_u32 s58, s54, 21504
  buffer_load_dwordx4 v15, s[28:31], s58 offen offset:3072 lds
  s_mul_i32 s52, s68, 2
  s_lshl_b32 s53, s52, 12
  s_add_u32 s53, s53, 69632
  s_add_u32 s52, s52, 9
  s_lshr_b32 s54, s52, 1
  s_mul_i32 s54, s54, 3
  s_and_b32 s58, s52, 1
  s_add_u32 s54, s54, s58
  s_mul_i32 s58, s52, 3
  s_sub_u32 s58, s58, 85
  s_cmp_le_u32 s52, 28
  s_cselect_b32 s54, s54, s58
  s_lshl_b32 s54, s54, 15
  s_mov_b32 m0, s53
  s_add_u32 s58, s54, 0
  buffer_load_dwordx4 v15, s[28:31], s58 offen offset:0 lds
  s_add_u32 s58, s54, 7168
  buffer_load_dwordx4 v15, s[28:31], s58 offen offset:1024 lds
  s_add_u32 s58, s54, 14336
  buffer_load_dwordx4 v15, s[28:31], s58 offen offset:2048 lds
  s_add_u32 s58, s54, 21504
  buffer_load_dwordx4 v15, s[28:31], s58 offen offset:3072 lds
  buffer_load_dword v30, v1, s[40:43], 0 offen sc1
  s_barrier
  s_mul_i32 s52, s68, 2
  s_lshl_b32 s53, s52, 12
  s_add_u32 s53, s53, 98304
  s_add_u32 s52, s52, 16
  s_lshr_b32 s54, s52, 1
  s_mul_i32 s54, s54, 3
  s_and_b32 s58, s52, 1
  s_add_u32 s54, s54, s58
  s_mul_i32 s58, s52, 3
  s_sub_u32 s58, s58, 85
  s_cmp_le_u32 s52, 28
  s_cselect_b32 s54, s54, s58
  s_lshl_b32 s54, s54, 15
  s_mov_b32 m0, s53
  s_add_u32 s58, s54, 0
  buffer_load_dwordx4 v15, s[28:31], s58 offen offset:0 lds
  s_add_u32 s58, s54, 7168
  buffer_load_dwordx4 v15, s[28:31], s58 offen offset:1024 lds
  s_add_u32 s58, s54, 14336
  buffer_load_dwordx4 v15, s[28:31], s58 offen offset:2048 lds
  s_add_u32 s58, s54, 21504
  buffer_load_dwordx4 v15, s[28:31], s58 offen offset:3072 lds
  s_mul_i32 s52, s68, 2
  s_lshl_b32 s53, s52, 12
  s_add_u32 s53, s53, 102400
  s_add_u32 s52, s52, 17
  s_lshr_b32 s54, s52, 1
  s_mul_i32 s54, s54, 3
  s_and_b32 s58, s52, 1
  s_add_u32 s54, s54, s58
  s_mul_i32 s58, s52, 3
  s_sub_u32 s58, s58, 85
  s_cmp_le_u32 s52, 28
  s_cselect_b32 s54, s54, s58
  s_lshl_b32 s54, s54, 15
  s_mov_b32 m0, s53
  s_add_u32 s58, s54, 0
  buffer_load_dwordx4 v15, s[28:31], s58 offen offset:0 lds
  s_add_u32 s58, s54, 7168
  buffer_load_dwordx4 v15, s[28:31], s58 offen offset:1024 lds
  s_add_u32 s58, s54, 14336
  buffer_load_dwordx4 v15, s[28:31], s58 offen offset:2048 lds
  s_add_u32 s58, s54, 21504
  buffer_load_dwordx4 v15, s[28:31], s58 offen offset:3072 lds
  s_waitcnt vmcnt(25)
  s_barrier
  s_barrier
  s_mul_i32 s52, s68, 2
  s_lshl_b32 s53, s52, 12
  s_add_u32 s53, s53, 131072
  s_add_u32 s52, s52, 24
  s_lshr_b32 s54, s52, 1
  s_mul_i32 s54, s54, 3
  s_and_b32 s58, s52, 1
  s_add_u32 s54, s54, s58
  s_mul_i32 s58, s52, 3
  s_sub_u32 s58, s58, 85
  s_cmp_le_u32 s52, 28
  s_cselect_b32 s54, s54, s58
  s_lshl_b32 s54, s54, 15
  s_mov_b32 m0, s53
  s_add_u32 s58, s54, 0
  buffer_load_dwordx4 v15, s[28:31], s58 offen offset:0 lds
  s_add_u32 s58, s54, 7168
  buffer_load_dwordx4 v15, s[28:31], s58 offen offset:1024 lds
  s_add_u32 s58, s54, 14336
  buffer_load_dwordx4 v15, s[28:31], s58 offen offset:2048 lds
  s_add_u32 s58, s54, 21504
  buffer_load_dwordx4 v15, s[28:31], s58 offen offset:3072 lds
  s_mul_i32 s52, s68, 2
  s_lshl_b32 s53, s52, 12
  s_add_u32 s53, s53, 135168
  s_add_u32 s52, s52, 25
  s_lshr_b32 s54, s52, 1
  s_mul_i32 s54, s54, 3
  s_and_b32 s58, s52, 1
  s_add_u32 s54, s54, s58
  s_mul_i32 s58, s52, 3
  s_sub_u32 s58, s58, 85
  s_cmp_le_u32 s52, 28
  s_cselect_b32 s54, s54, s58
  s_lshl_b32 s54, s54, 15
  s_mov_b32 m0, s53
  s_add_u32 s58, s54, 0
  buffer_load_dwordx4 v15, s[28:31], s58 offen offset:0 lds
  s_add_u32 s58, s54, 7168
  buffer_load_dwordx4 v15, s[28:31], s58 offen offset:1024 lds
  s_add_u32 s58, s54, 14336
  buffer_load_dwordx4 v15, s[28:31], s58 offen offset:2048 lds
  s_add_u32 s58, s54, 21504
  buffer_load_dwordx4 v15, s[28:31], s58 offen offset:3072 lds
  s_cmp_lg_u32 s68, 0
  s_cbranch_scc1 L_tokdone
  s_waitcnt vmcnt(16)
  s_mov_b32 s58, 0
L_tok:
  v_readfirstlane_b32 s55, v30
  s_cmp_lg_u32 s55, 0
  s_cbranch_scc1 L_tokdone
  s_sleep 2
  buffer_load_dword v30, v1, s[40:43], 0 offen sc1
  s_waitcnt vmcnt(0)
  s_add_u32 s58, s58, 1
  s_cmp_lt_u32 s58, 0x100000
  s_cbranch_scc1 L_tok
L_tokdone:
  s_lshl_b32 s56, s45, 8
  s_lshl_b32 s57, s46, 2
  s_add_u32 s56, s56, s57
  s_add_u32 s56, s56, 6291456
  s_barrier
  s_cmp_lg_u32 s68, 0
  s_cbranch_scc1 L_noflagA
  s_mov_b64 exec, 1
  buffer_store_dword v30, v1, s[32:35], s56 offen sc1
  s_mov_b64 exec, -1
L_noflagA:
  s_barrier
  s_mul_i32 s52, s68, 2
  s_lshl_b32 s53, s52, 12
  s_add_u32 s53, s53, 0
  s_add_u32 s52, s52, 32
  s_lshr_b32 s54, s52, 1
  s_mul_i32 s54, s54, 3
  s_and_b32 s58, s52, 1
  s_add_u32 s54, s54, s58
  s_mul_i32 s58, s52, 3
  s_sub_u32 s58, s58, 85
  s_cmp_le_u32 s52, 28
  s_cselect_b32 s54, s54, s58
  s_lshl_b32 s54, s54, 15
  s_mov_b32 m0, s53
  s_add_u32 s58, s54, 0
  buffer_load_dwordx4 v15, s[28:31], s58 offen offset:0 lds
  s_add_u32 s58, s54, 7168
  buffer_load_dwordx4 v15, s[28:31], s58 offen offset:1024 lds
  s_add_u32 s58, s54, 14336
  buffer_load_dwordx4 v15, s[28:31], s58 offen offset:2048 lds
  s_add_u32 s58, s54, 21504
  buffer_load_dwordx4 v15, s[28:31], s58 offen offset:3072 lds
  s_mul_i32 s52, s68, 2
  s_lshl_b32 s53, s52, 12
  s_add_u32 s53, s53, 4096
  s_add_u32 s52, s52, 33
  s_lshr_b32 s54, s52, 1
  s_mul_i32 s54, s54, 3
  s_and_b32 s58, s52, 1
  s_add_u32 s54, s54, s58
  s_mul_i32 s58, s52, 3
  s_sub_u32 s58, s58, 85
  s_cmp_le_u32 s52, 28
  s_cselect_b32 s54, s54, s58
  s_lshl_b32 s54, s54, 15
  s_mov_b32 m0, s53
  s_add_u32 s58, s54, 0
  buffer_load_dwordx4 v15, s[28:31], s58 offen offset:0 lds
  s_add_u32 s58, s54, 7168
  buffer_load_dwordx4 v15, s[28:31], s58 offen offset:1024 lds
  s_add_u32 s58, s54, 14336
  buffer_load_dwordx4 v15, s[28:31], s58 offen offset:2048 lds
  s_add_u32 s58, s54, 21504
  buffer_load_dwordx4 v15, s[28:31], s58 offen offset:3072 lds
  s_branch L_join_l
L_idle_l:
  buffer_load_dword v30, v1, s[40:43], 0 offen sc1
  s_mul_i32 s52, s68, 2
  s_lshl_b32 s53, s52, 12
  s_add_u32 s53, s53, 32768
  s_add_u32 s52, s52, 0
  s_lshr_b32 s54, s52, 1
  s_mul_i32 s54, s54, 3
  s_and_b32 s58, s52, 1
  s_add_u32 s54, s54, s58
  s_mul_i32 s58, s52, 3
  s_sub_u32 s58, s58, 85
  s_cmp_le_u32 s52, 28
  s_cselect_b32 s54, s54, s58
  s_lshl_b32 s54, s54, 15
  s_mov_b32 m0, s53
  s_add_u32 s58, s54, 0
  buffer_load_dwordx4 v15, s[28:31], s58 offen offset:0 lds
  s_add_u32 s58, s54, 7168
  buffer_load_dwordx4 v15, s[28:31], s58 offen offset:1024 lds
  s_add_u32 s58, s54, 14336
  buffer_load_dwordx4 v15, s[28:31], s58 offen offset:2048 lds
  s_add_u32 s58, s54, 21504
  buffer_load_dwordx4 v15, s[28:31], s58 offen offset:3072 lds
  s_mul_i32 s52, s68, 2
  s_lshl_b32 s53, s52, 12
  s_add_u32 s53, s53, 36864
  s_add_u32 s52, s52, 1
  s_lshr_b32 s54, s52, 1
  s_mul_i32 s54, s54, 3
  s_and_b32 s58, s52, 1
  s_add_u32 s54, s54, s58
  s_mul_i32 s58, s52, 3
  s_sub_u32 s58, s58, 85
  s_cmp_le_u32 s52, 28
  s_cselect_b32 s54, s54, s58
  s_lshl_b32 s54, s54, 15
  s_mov_b32 m0, s53
  s_add_u32 s58, s54, 0
  buffer_load_dwordx4 v15, s[28:31], s58 offen offset:0 lds
  s_add_u32 s58, s54, 7168
  buffer_load_dwordx4 v15, s[28:31], s58 offen offset:1024 lds
  s_add_u32 s58, s54, 14336
  buffer_load_dwordx4 v15, s[28:31], s58 offen offset:2048 lds
  s_add_u32 s58, s54, 21504
  buffer_load_dwordx4 v15, s[28:31], s58 offen offset:3072 lds
  s_mul_i32 s52, s68, 2
  s_lshl_b32 s53, s52, 12
  s_add_u32 s53, s53, 65536
  s_add_u32 s52, s52, 8
  s_lshr_b32 s54, s52, 1
  s_mul_i32 s54, s54, 3
  s_and_b32 s58, s52, 1
  s_add_u32 s54, s54, s58
  s_mul_i32 s58, s52, 3
  s_sub_u32 s58, s58, 85
  s_cmp_le_u32 s52, 28
  s_cselect_b32 s54, s54, s58
  s_lshl_b32 s54, s54, 15
  s_mov_b32 m0, s53
  s_add_u32 s58, s54, 0
  buffer_load_dwordx4 v15, s[28:31], s58 offen offset:0 lds
  s_add_u32 s58, s54, 7168
  buffer_load_dwordx4 v15, s[28:31], s58 offen offset:1024 lds
  s_add_u32 s58, s54, 14336
  buffer_load_dwordx4 v15, s[28:31], s58 offen offset:2048 lds
  s_add_u32 s58, s54, 21504
  buffer_load_dwordx4 v15, s[28:31], s58 offen offset:3072 lds
  s_mul_i32 s52, s68, 2
  s_lshl_b32 s53, s52, 12
  s_add_u32 s53, s53, 69632
  s_add_u32 s52, s52, 9
  s_lshr_b32 s54, s52, 1
  s_mul_i32 s54, s54, 3
  s_and_b32 s58, s52, 1
  s_add_u32 s54, s54, s58
  s_mul_i32 s58, s52, 3
  s_sub_u32 s58, s58, 85
  s_cmp_le_u32 s52, 28
  s_cselect_b32 s54, s54, s58
  s_lshl_b32 s54, s54, 15
  s_mov_b32 m0, s53
  s_add_u32 s58, s54, 0
  buffer_load_dwordx4 v15, s[28:31], s58 offen offset:0 lds
  s_add_u32 s58, s54, 7168
  buffer_load_dwordx4 v15, s[28:31], s58 offen offset:1024 lds
  s_add_u32 s58, s54, 14336
  buffer_load_dwordx4 v15, s[28:31], s58 offen offset:2048 lds
  s_add_u32 s58, s54, 21504
  buffer_load_dwordx4 v15, s[28:31], s58 offen offset:3072 lds
  s_mul_i32 s52, s68, 2
  s_lshl_b32 s53, s52, 12
  s_add_u32 s53, s53, 98304
  s_add_u32 s52, s52, 16
  s_lshr_b32 s54, s52, 1
  s_mul_i32 s54, s54, 3
  s_and_b32 s58, s52, 1
  s_add_u32 s54, s54, s58
  s_mul_i32 s58, s52, 3
  s_sub_u32 s58, s58, 85
  s_cmp_le_u32 s52, 28
  s_cselect_b32 s54, s54, s58
  s_lshl_b32 s54, s54, 15
  s_mov_b32 m0, s53
  s_add_u32 s58, s54, 0
  buffer_load_dwordx4 v15, s[28:31], s58 offen offset:0 lds
  s_add_u32 s58, s54, 7168
  buffer_load_dwordx4 v15, s[28:31], s58 offen offset:1024 lds
  s_add_u32 s58, s54, 14336
  buffer_load_dwordx4 v15, s[28:31], s58 offen offset:2048 lds
  s_add_u32 s58, s54, 21504
  buffer_load_dwordx4 v15, s[28:31], s58 offen offset:3072 lds
  s_mul_i32 s52, s68, 2
  s_lshl_b32 s53, s52, 12
  s_add_u32 s53, s53, 102400
  s_add_u32 s52, s52, 17
  s_lshr_b32 s54, s52, 1
  s_mul_i32 s54, s54, 3
  s_and_b32 s58, s52, 1
  s_add_u32 s54, s54, s58
  s_mul_i32 s58, s52, 3
  s_sub_u32 s58, s58, 85
  s_cmp_le_u32 s52, 28
  s_cselect_b32 s54, s54, s58
  s_lshl_b32 s54, s54, 15
  s_mov_b32 m0, s53
  s_add_u32 s58, s54, 0
  buffer_load_dwordx4 v15, s[28:31], s58 offen offset:0 lds
  s_add_u32 s58, s54, 7168
  buffer_load_dwordx4 v15, s[28:31], s58 offen offset:1024 lds
  s_add_u32 s58, s54, 14336
  buffer_load_dwordx4 v15, s[28:31], s58 offen offset:2048 lds
  s_add_u32 s58, s54, 21504
  buffer_load_dwordx4 v15, s[28:31], s58 offen offset:3072 lds
  s_mul_i32 s52, s68, 2
  s_lshl_b32 s53, s52, 12
  s_add_u32 s53, s53, 131072
  s_add_u32 s52, s52, 24
  s_lshr_b32 s54, s52, 1
  s_mul_i32 s54, s54, 3
  s_and_b32 s58, s52, 1
  s_add_u32 s54, s54, s58
  s_mul_i32 s58, s52, 3
  s_sub_u32 s58, s58, 85
  s_cmp_le_u32 s52, 28
  s_cselect_b32 s54, s54, s58
  s_lshl_b32 s54, s54, 15
  s_mov_b32 m0, s53
  s_add_u32 s58, s54, 0
  buffer_load_dwordx4 v15, s[28:31], s58 offen offset:0 lds
  s_add_u32 s58, s54, 7168
  buffer_load_dwordx4 v15, s[28:31], s58 offen offset:1024 lds
  s_add_u32 s58, s54, 14336
  buffer_load_dwordx4 v15, s[28:31], s58 offen offset:2048 lds
  s_add_u32 s58, s54, 21504
  buffer_load_dwordx4 v15, s[28:31], s58 offen offset:3072 lds
  s_mul_i32 s52, s68, 2
  s_lshl_b32 s53, s52, 12
  s_add_u32 s53, s53, 135168
  s_add_u32 s52, s52, 25
  s_lshr_b32 s54, s52, 1
  s_mul_i32 s54, s54, 3
  s_and_b32 s58, s52, 1
  s_add_u32 s54, s54, s58
  s_mul_i32 s58, s52, 3
  s_sub_u32 s58, s58, 85
  s_cmp_le_u32 s52, 28
  s_cselect_b32 s54, s54, s58
  s_lshl_b32 s54, s54, 15
  s_mov_b32 m0, s53
  s_add_u32 s58, s54, 0
  buffer_load_dwordx4 v15, s[28:31], s58 offen offset:0 lds
  s_add_u32 s58, s54, 7168
  buffer_load_dwordx4 v15, s[28:31], s58 offen offset:1024 lds
  s_add_u32 s58, s54, 14336
  buffer_load_dwordx4 v15, s[28:31], s58 offen offset:2048 lds
  s_add_u32 s58, s54, 21504
  buffer_load_dwordx4 v15, s[28:31], s58 offen offset:3072 lds
  s_mul_i32 s52, s68, 2
  s_lshl_b32 s53, s52, 12
  s_add_u32 s53, s53, 0
  s_add_u32 s52, s52, 32
  s_lshr_b32 s54, s52, 1
  s_mul_i32 s54, s54, 3
  s_and_b32 s58, s52, 1
  s_add_u32 s54, s54, s58
  s_mul_i32 s58, s52, 3
  s_sub_u32 s58, s58, 85
  s_cmp_le_u32 s52, 28
  s_cselect_b32 s54, s54, s58
  s_lshl_b32 s54, s54, 15
  s_mov_b32 m0, s53
  s_add_u32 s58, s54, 0
  buffer_load_dwordx4 v15, s[28:31], s58 offen offset:0 lds
  s_add_u32 s58, s54, 7168
  buffer_load_dwordx4 v15, s[28:31], s58 offen offset:1024 lds
  s_add_u32 s58, s54, 14336
  buffer_load_dwordx4 v15, s[28:31], s58 offen offset:2048 lds
  s_add_u32 s58, s54, 21504
  buffer_load_dwordx4 v15, s[28:31], s58 offen offset:3072 lds
  s_mul_i32 s52, s68, 2
  s_lshl_b32 s53, s52, 12
  s_add_u32 s53, s53, 4096
  s_add_u32 s52, s52, 33
  s_lshr_b32 s54, s52, 1
  s_mul_i32 s54, s54, 3
  s_and_b32 s58, s52, 1
  s_add_u32 s54, s54, s58
  s_mul_i32 s58, s52, 3
  s_sub_u32 s58, s58, 85
  s_cmp_le_u32 s52, 28
  s_cselect_b32 s54, s54, s58
  s_lshl_b32 s54, s54, 15
  s_mov_b32 m0, s53
  s_add_u32 s58, s54, 0
  buffer_load_dwordx4 v15, s[28:31], s58 offen offset:0 lds
  s_add_u32 s58, s54, 7168
  buffer_load_dwordx4 v15, s[28:31], s58 offen offset:1024 lds
  s_add_u32 s58, s54, 14336
  buffer_load_dwordx4 v15, s[28:31], s58 offen offset:2048 lds
  s_add_u32 s58, s54, 21504
  buffer_load_dwordx4 v15, s[28:31], s58 offen offset:3072 lds
  s_cmp_lg_u32 s68, 0
  s_cbranch_scc1 L_join_l
  s_waitcnt vmcnt(40)
  s_mov_b32 s58, 0
L_tok2:
  v_readfirstlane_b32 s55, v30
  s_cmp_lg_u32 s55, 0
  s_cbranch_scc1 L_join_l
  s_sleep 2
  buffer_load_dword v30, v1, s[40:43], 0 offen sc1
  s_waitcnt vmcnt(0)
  s_add_u32 s58, s58, 1
  s_cmp_lt_u32 s58, 0x100000
  s_cbranch_scc1 L_tok2
L_join_l:
  s_barrier
  s_cmp_lg_u32 s68, 0
  s_cbranch_scc1 L_nopollA
  s_cmp_ge_u32 s46, 14
  s_cbranch_scc1 L_noflagB
  s_add_u32 s56, s56, 128
  s_mov_b64 exec, 1
  buffer_store_dword v30, v1, s[32:35], s56 offen sc1
  s_mov_b64 exec, -1
L_noflagB:
  s_lshr_b32 s57, s47, 1
  s_lshl_b32 s57, s57, 8
  s_add_u32 s57, s57, 6291456
  v_lshlrev_b32 v8, 2, v2
  s_mov_b64 exec, 0x7fff
  s_mov_b32 s58, 0
L_pollA:
  buffer_load_dword v9, v8, s[32:35], s57 offen sc1
  s_waitcnt vmcnt(0)
  v_cmp_ne_u32 vcc, s55, v9
  s_cmp_eq_u64 vcc, 0
  s_cbranch_scc1 L_pollokA
  s_sleep 1
  s_add_u32 s58, s58, 1
  s_cmp_lt_u32 s58, 0x100000
  s_cbranch_scc1 L_pollA
L_pollokA:
  s_mov_b64 exec, -1
L_nopollA:
  s_waitcnt vmcnt(8)
  s_barrier
  s_barrier
  s_mul_i32 s52, s68, 1
  s_lshl_b32 s53, s52, 12
  s_add_u32 s53, s53, 32768
  s_add_u32 s52, s52, 40
  s_lshr_b32 s54, s52, 1
  s_mul_i32 s54, s54, 3
  s_and_b32 s58, s52, 1
  s_add_u32 s54, s54, s58
  s_mul_i32 s58, s52, 3
  s_sub_u32 s58, s58, 85
  s_cmp_le_u32 s52, 28
  s_cselect_b32 s54, s54, s58
  s_lshl_b32 s54, s54, 15
  s_mov_b32 m0, s53
  s_add_u32 s58, s54, 0
  buffer_load_dwordx4 v15, s[28:31], s58 offen offset:0 lds
  s_add_u32 s58, s54, 7168
  buffer_load_dwordx4 v15, s[28:31], s58 offen offset:1024 lds
  s_add_u32 s58, s54, 14336
  buffer_load_dwordx4 v15, s[28:31], s58 offen offset:2048 lds
  s_add_u32 s58, s54, 21504
  buffer_load_dwordx4 v15, s[28:31], s58 offen offset:3072 lds
  s_cmp_lg_u32 s68, 0
  s_cbranch_scc1 L_nopollB
  s_lshr_b32 s57, s47, 1
  s_lshl_b32 s57, s57, 8
  s_add_u32 s57, s57, 6291584
  v_lshlrev_b32 v8, 2, v2
  s_mov_b64 exec, 0x3fff
  s_mov_b32 s58, 0
L_pollB:
  buffer_load_dword v9, v8, s[32:35], s57 offen sc1
  s_waitcnt vmcnt(0)
  v_cmp_ne_u32 vcc, s55, v9
  s_cmp_eq_u64 vcc, 0
  s_cbranch_scc1 L_pollokB
  s_sleep 1
  s_add_u32 s58, s58, 1
  s_cmp_lt_u32 s58, 0x100000
  s_cbranch_scc1 L_pollB
L_pollokB:
  s_mov_b64 exec, -1
L_nopollB:
  s_waitcnt vmcnt(0)
  s_barrier
  s_barrier
  s_barrier
L_done:
  s_endpgm
L_compute:
  s_lshr_b32 s66, s44, 1
  s_and_b32 s67, s44, 1
  v_lshlrev_b32 v28, 4, v2
  v_and_b32 v30, 15, v2
  v_lshlrev_b32 v30, 7, v30
  v_bfe_u32 v31, v2, 1, 3
  v_xor_b32 v31, v31, v4
  v_lshl_add_u32 v30, v31, 4, v30
  s_lshl_b32 s52, s44, 11
  v_add_u32 v5, s52, v30
  v_xor_b32 v6, 64, v5
  v_xor_b32 v7, 0x800, v5
  v_xor_b32 v8, 0x800, v6
  v_add_u32 v9, 0x10000, v5
  v_add_u32 v10, 0x10000, v6
  v_add_u32 v11, 0x10000, v7
  v_add_u32 v12, 0x10000, v8
  v_bfe_u32 v30, v2, 2, 2
  v_bfe_u32 v31, v2, 4, 1
  v_lshl_add_u32 v30, v31, 2, v30
  v_lshrrev_b32 v31, 5, v2
  v_lshl_add_u32 v30, v31, 4, v30
  v_lshlrev_b32 v30, 7, v30
  v_and_b32 v31, 3, v2
  v_lshl_add_u32 v30, v31, 3, v30
  v_bfe_u32 v31, v2, 3, 2
  v_xor_b32 v25, 0, v31
  v_lshl_add_u32 v17, v25, 5, v30
  v_add_u32 v21, 0x20000, v17
  v_xor_b32 v25, 1, v31
  v_lshl_add_u32 v18, v25, 5, v30
  v_add_u32 v22, 0x20000, v18
  v_xor_b32 v25, 2, v31
  v_lshl_add_u32 v19, v25, 5, v30
  v_add_u32 v23, 0x20000, v19
  v_xor_b32 v25, 3, v31
  v_lshl_add_u32 v20, v25, 5, v30
  v_add_u32 v24, 0x20000, v20
  s_lshl_b32 s52, s67, 1
  v_xor_b32 v25, s52, v31
  v_lshl_add_u32 v13, v25, 5, v30
  v_add_u32 v13, 16384, v13
  v_xor_b32 v14, 32, v13
  v_add_u32 v15, 0x10000, v13
  v_add_u32 v16, 0x10000, v14
  v_mov_b32 v136, 0
  v_mov_b32 v137, 0
  v_mov_b32 v138, 0
  v_mov_b32 v139, 0
  v_mov_b32 v140, 0
  v_mov_b32 v141, 0
  v_mov_b32 v142, 0
  v_mov_b32 v143, 0
  v_mov_b32 v144, 0
  v_mov_b32 v145, 0
  v_mov_b32 v146, 0
  v_mov_b32 v147, 0
  v_mov_b32 v148, 0
  v_mov_b32 v149, 0
  v_mov_b32 v150, 0
  v_mov_b32 v151, 0
  v_mov_b32 v152, 0
  v_mov_b32 v153, 0
  v_mov_b32 v154, 0
  v_mov_b32 v155, 0
  v_mov_b32 v156, 0
  v_mov_b32 v157, 0
  v_mov_b32 v158, 0
  v_mov_b32 v159, 0
  v_mov_b32 v160, 0
  v_mov_b32 v161, 0
  v_mov_b32 v162, 0
  v_mov_b32 v163, 0
  v_mov_b32 v164, 0
  v_mov_b32 v165, 0
  v_mov_b32 v166, 0
  v_mov_b32 v167, 0
  s_lshl_b32 s52, s45, 3
  s_add_u32 s53, s52, s44
  s_xor_b32 s54, s53, 1
  s_mul_i32 s53, s53, 43
  s_mul_i32 s54, s54, 43
  s_mul_i32 s52, s46, 3
  s_add_u32 s53, s53, s52
  s_add_u32 s54, s54, s52
  s_add_u32 s55, s53, 2
  s_lshl_b32 s55, s55, 10
  s_add_u32 s53, s53, s67
  s_lshl_b32 s53, s53, 10
  s_add_u32 s54, s54, s67
  s_lshl_b32 s54, s54, 10
  s_mov_b32 s68, 0xbfb8aa3b
  s_mov_b32 s69, 0xbfb8aa3b
  s_mov_b32 s50, 1.0
  s_mov_b32 s51, 1.0
  s_cmp_eq_u32 s46, 14
  s_cselect_b32 s57, s67, 0
  s_waitcnt lgkmcnt(0)
  s_mov_b32 s32, s16
  s_and_b32 s33, s17, 0xffff
  s_mov_b32 s34, 8388608
  s_mov_b32 s35, 0x20000
  s_mov_b32 s36, s12
  s_and_b32 s37, s13, 0xffff
  s_mov_b32 s38, 2097152
  s_mov_b32 s39, 0x20000
  s_cmp_ge_u32 s46, 15
  s_cbranch_scc1 L_join
  s_barrier
  ds_read_b128 v[72:75], v5 offset:0
  ds_read_b128 v[32:35], v7 offset:0
  ds_read_b64_tr_b16 v[36:37], v13 offset:0
  ds_read_b64_tr_b16 v[38:39], v13 offset:1024
  ds_read_b64_tr_b16 v[40:41], v14 offset:0
  ds_read_b64_tr_b16 v[42:43], v14 offset:1024
  ds_read_b64_tr_b16 v[44:45], v13 offset:8192
  ds_read_b64_tr_b16 v[46:47], v13 offset:9216
  ds_read_b64_tr_b16 v[48:49], v14 offset:8192
  ds_read_b64_tr_b16 v[50:51], v14 offset:9216
  s_waitcnt lgkmcnt(6)
  v_mfma_f32_16x16x32_bf16 v[136:139], v[36:39], v[72:75], v[136:139]
  ds_read_b128 v[76:79], v6 offset:0
  ds_read_b128 v[52:55], v8 offset:0
  s_waitcnt lgkmcnt(8)
  v_mfma_f32_16x16x32_bf16 v[144:147], v[36:39], v[32:35], v[144:147]
  ds_read_b64_tr_b16 v[56:57], v13 offset:4096
  s_waitcnt lgkmcnt(7)
  v_mfma_f32_16x16x32_bf16 v[140:143], v[40:43], v[72:75], v[140:143]
  ds_read_b64_tr_b16 v[58:59], v13 offset:5120
  s_waitcnt lgkmcnt(8)
  v_mfma_f32_16x16x32_bf16 v[148:151], v[40:43], v[32:35], v[148:151]
  ds_read_b64_tr_b16 v[60:61], v14 offset:4096
  s_waitcnt lgkmcnt(7)
  v_mfma_f32_16x16x32_bf16 v[152:155], v[44:47], v[72:75], v[152:155]
  ds_read_b64_tr_b16 v[62:63], v14 offset:5120
  ds_read_b64_tr_b16 v[64:65], v13 offset:12288
  s_waitcnt lgkmcnt(9)
  v_mfma_f32_16x16x32_bf16 v[160:163], v[44:47], v[32:35], v[160:163]
  ds_read_b64_tr_b16 v[66:67], v13 offset:13312
  s_waitcnt lgkmcnt(8)
  v_mfma_f32_16x16x32_bf16 v[156:159], v[48:51], v[72:75], v[156:159]
  ds_read_b64_tr_b16 v[68:69], v14 offset:12288
  s_waitcnt lgkmcnt(9)
  v_mfma_f32_16x16x32_bf16 v[164:167], v[48:51], v[32:35], v[164:167]
  ds_read_b64_tr_b16 v[70:71], v14 offset:13312
  s_barrier
  s_waitcnt lgkmcnt(6)
  v_mfma_f32_16x16x32_bf16 v[136:139], v[56:59], v[76:79], v[136:139]
  ds_read_b128 v[80:83], v5 offset:32768
  ds_read_b128 v[32:35], v7 offset:32768
  s_waitcnt lgkmcnt(8)
  v_mfma_f32_16x16x32_bf16 v[144:147], v[56:59], v[52:55], v[144:147]
  ds_read_b64_tr_b16 v[36:37], v13 offset:32768
  s_waitcnt lgkmcnt(7)
  v_mfma_f32_16x16x32_bf16 v[140:143], v[60:63], v[76:79], v[140:143]
  ds_read_b64_tr_b16 v[38:39], v13 offset:33792
  s_waitcnt lgkmcnt(8)
  v_mfma_f32_16x16x32_bf16 v[148:151], v[60:63], v[52:55], v[148:151]
  ds_read_b64_tr_b16 v[40:41], v14 offset:32768
  s_waitcnt lgkmcnt(7)
  v_mfma_f32_16x16x32_bf16 v[152:155], v[64:67], v[76:79], v[152:155]
  ds_read_b64_tr_b16 v[42:43], v14 offset:33792
  ds_read_b64_tr_b16 v[44:45], v13 offset:40960
  s_waitcnt lgkmcnt(9)
  v_mfma_f32_16x16x32_bf16 v[160:163], v[64:67], v[52:55], v[160:163]
  ds_read_b64_tr_b16 v[46:47], v13 offset:41984
  s_waitcnt lgkmcnt(8)
  v_mfma_f32_16x16x32_bf16 v[156:159], v[68:71], v[76:79], v[156:159]
  ds_read_b64_tr_b16 v[48:49], v14 offset:40960
  s_waitcnt lgkmcnt(9)
  v_mfma_f32_16x16x32_bf16 v[164:167], v[68:71], v[52:55], v[164:167]
  ds_read_b64_tr_b16 v[50:51], v14 offset:41984
  s_waitcnt lgkmcnt(6)
  v_mfma_f32_16x16x32_bf16 v[136:139], v[36:39], v[80:83], v[136:139]
  ds_read_b128 v[84:87], v6 offset:32768
  ds_read_b128 v[52:55], v8 offset:32768
  s_waitcnt lgkmcnt(8)
  v_mfma_f32_16x16x32_bf16 v[144:147], v[36:39], v[32:35], v[144:147]
  ds_read_b64_tr_b16 v[56:57], v13 offset:36864
  s_waitcnt lgkmcnt(7)
  v_mfma_f32_16x16x32_bf16 v[140:143], v[40:43], v[80:83], v[140:143]
  ds_read_b64_tr_b16 v[58:59], v13 offset:37888
  s_waitcnt lgkmcnt(8)
  v_mfma_f32_16x16x32_bf16 v[148:151], v[40:43], v[32:35], v[148:151]
  ds_read_b64_tr_b16 v[60:61], v14 offset:36864
  s_waitcnt lgkmcnt(7)
  v_mfma_f32_16x16x32_bf16 v[152:155], v[44:47], v[80:83], v[152:155]
  ds_read_b64_tr_b16 v[62:63], v14 offset:37888
  ds_read_b64_tr_b16 v[64:65], v13 offset:45056
  s_waitcnt lgkmcnt(9)
  v_mfma_f32_16x16x32_bf16 v[160:163], v[44:47], v[32:35], v[160:163]
  ds_read_b64_tr_b16 v[66:67], v13 offset:46080
  s_waitcnt lgkmcnt(8)
  v_mfma_f32_16x16x32_bf16 v[156:159], v[48:51], v[80:83], v[156:159]
  ds_read_b64_tr_b16 v[68:69], v14 offset:45056
  s_waitcnt lgkmcnt(9)
  v_mfma_f32_16x16x32_bf16 v[164:167], v[48:51], v[32:35], v[164:167]
  ds_read_b64_tr_b16 v[70:71], v14 offset:46080
  s_barrier
  s_waitcnt lgkmcnt(6)
  v_mfma_f32_16x16x32_bf16 v[136:139], v[56:59], v[84:87], v[136:139]
  ds_read_b128 v[88:91], v9 offset:0
  ds_read_b128 v[32:35], v11 offset:0
  s_waitcnt lgkmcnt(8)
  v_mfma_f32_16x16x32_bf16 v[144:147], v[56:59], v[52:55], v[144:147]
  ds_read_b64_tr_b16 v[36:37], v15 offset:0
  s_waitcnt lgkmcnt(7)
  v_mfma_f32_16x16x32_bf16 v[140:143], v[60:63], v[84:87], v[140:143]
  ds_read_b64_tr_b16 v[38:39], v15 offset:1024
  s_waitcnt lgkmcnt(8)
  v_mfma_f32_16x16x32_bf16 v[148:151], v[60:63], v[52:55], v[148:151]
  ds_read_b64_tr_b16 v[40:41], v16 offset:0
  s_waitcnt lgkmcnt(7)
  v_mfma_f32_16x16x32_bf16 v[152:155], v[64:67], v[84:87], v[152:155]
  ds_read_b64_tr_b16 v[42:43], v16 offset:1024
  ds_read_b64_tr_b16 v[44:45], v15 offset:8192
  s_waitcnt lgkmcnt(9)
  v_mfma_f32_16x16x32_bf16 v[160:163], v[64:67], v[52:55], v[160:163]
  ds_read_b64_tr_b16 v[46:47], v15 offset:9216
  s_waitcnt lgkmcnt(8)
  v_mfma_f32_16x16x32_bf16 v[156:159], v[68:71], v[84:87], v[156:159]
  ds_read_b64_tr_b16 v[48:49], v16 offset:8192
  s_waitcnt lgkmcnt(9)
  v_mfma_f32_16x16x32_bf16 v[164:167], v[68:71], v[52:55], v[164:167]
  ds_read_b64_tr_b16 v[50:51], v16 offset:9216
  s_waitcnt lgkmcnt(6)
  v_mfma_f32_16x16x32_bf16 v[136:139], v[36:39], v[88:91], v[136:139]
  ds_read_b128 v[92:95], v10 offset:0
  ds_read_b128 v[52:55], v12 offset:0
  s_waitcnt lgkmcnt(8)
  v_mfma_f32_16x16x32_bf16 v[144:147], v[36:39], v[32:35], v[144:147]
  ds_read_b64_tr_b16 v[56:57], v15 offset:4096
  s_waitcnt lgkmcnt(7)
  v_mfma_f32_16x16x32_bf16 v[140:143], v[40:43], v[88:91], v[140:143]
  ds_read_b64_tr_b16 v[58:59], v15 offset:5120
  s_waitcnt lgkmcnt(8)
  v_mfma_f32_16x16x32_bf16 v[148:151], v[40:43], v[32:35], v[148:151]
  ds_read_b64_tr_b16 v[60:61], v16 offset:4096
  s_waitcnt lgkmcnt(7)
  v_mfma_f32_16x16x32_bf16 v[152:155], v[44:47], v[88:91], v[152:155]
  ds_read_b64_tr_b16 v[62:63], v16 offset:5120
  ds_read_b64_tr_b16 v[64:65], v15 offset:12288
  s_waitcnt lgkmcnt(9)
  v_mfma_f32_16x16x32_bf16 v[160:163], v[44:47], v[32:35], v[160:163]
  ds_read_b64_tr_b16 v[66:67], v15 offset:13312
  s_waitcnt lgkmcnt(8)
  v_mfma_f32_16x16x32_bf16 v[156:159], v[48:51], v[88:91], v[156:159]
  ds_read_b64_tr_b16 v[68:69], v16 offset:12288
  s_waitcnt lgkmcnt(9)
  v_mfma_f32_16x16x32_bf16 v[164:167], v[48:51], v[32:35], v[164:167]
  ds_read_b64_tr_b16 v[70:71], v16 offset:13312
  s_barrier
  s_waitcnt lgkmcnt(6)
  v_mfma_f32_16x16x32_bf16 v[136:139], v[56:59], v[92:95], v[136:139]
  ds_read_b128 v[96:99], v9 offset:32768
  ds_read_b128 v[32:35], v11 offset:32768
  s_waitcnt lgkmcnt(8)
  v_mfma_f32_16x16x32_bf16 v[144:147], v[56:59], v[52:55], v[144:147]
  ds_read_b64_tr_b16 v[36:37], v15 offset:32768
  s_waitcnt lgkmcnt(7)
  v_mfma_f32_16x16x32_bf16 v[140:143], v[60:63], v[92:95], v[140:143]
  ds_read_b64_tr_b16 v[38:39], v15 offset:33792
  s_waitcnt lgkmcnt(8)
  v_mfma_f32_16x16x32_bf16 v[148:151], v[60:63], v[52:55], v[148:151]
  ds_read_b64_tr_b16 v[40:41], v16 offset:32768
  s_waitcnt lgkmcnt(7)
  v_mfma_f32_16x16x32_bf16 v[152:155], v[64:67], v[92:95], v[152:155]
  ds_read_b64_tr_b16 v[42:43], v16 offset:33792
  ds_read_b64_tr_b16 v[44:45], v15 offset:40960
  s_waitcnt lgkmcnt(9)
  v_mfma_f32_16x16x32_bf16 v[160:163], v[64:67], v[52:55], v[160:163]
  ds_read_b64_tr_b16 v[46:47], v15 offset:41984
  s_waitcnt lgkmcnt(8)
  v_mfma_f32_16x16x32_bf16 v[156:159], v[68:71], v[92:95], v[156:159]
  ds_read_b64_tr_b16 v[48:49], v16 offset:40960
  s_waitcnt lgkmcnt(9)
  v_mfma_f32_16x16x32_bf16 v[164:167], v[68:71], v[52:55], v[164:167]
  ds_read_b64_tr_b16 v[50:51], v16 offset:41984
  s_waitcnt lgkmcnt(6)
  v_mfma_f32_16x16x32_bf16 v[136:139], v[36:39], v[96:99], v[136:139]
  ds_read_b128 v[100:103], v10 offset:32768
  ds_read_b128 v[52:55], v12 offset:32768
  s_waitcnt lgkmcnt(8)
  v_mfma_f32_16x16x32_bf16 v[144:147], v[36:39], v[32:35], v[144:147]
  ds_read_b64_tr_b16 v[56:57], v15 offset:36864
  s_waitcnt lgkmcnt(7)
  v_mfma_f32_16x16x32_bf16 v[140:143], v[40:43], v[96:99], v[140:143]
  ds_read_b64_tr_b16 v[58:59], v15 offset:37888
  s_waitcnt lgkmcnt(8)
  v_mfma_f32_16x16x32_bf16 v[148:151], v[40:43], v[32:35], v[148:151]
  ds_read_b64_tr_b16 v[60:61], v16 offset:36864
  s_waitcnt lgkmcnt(7)
  v_mfma_f32_16x16x32_bf16 v[152:155], v[44:47], v[96:99], v[152:155]
  ds_read_b64_tr_b16 v[62:63], v16 offset:37888
  ds_read_b64_tr_b16 v[64:65], v15 offset:45056
  s_waitcnt lgkmcnt(9)
  v_mfma_f32_16x16x32_bf16 v[160:163], v[44:47], v[32:35], v[160:163]
  ds_read_b64_tr_b16 v[66:67], v15 offset:46080
  s_waitcnt lgkmcnt(8)
  v_mfma_f32_16x16x32_bf16 v[156:159], v[48:51], v[96:99], v[156:159]
  ds_read_b64_tr_b16 v[68:69], v16 offset:45056
  s_waitcnt lgkmcnt(9)
  v_mfma_f32_16x16x32_bf16 v[164:167], v[48:51], v[32:35], v[164:167]
  ds_read_b64_tr_b16 v[70:71], v16 offset:46080
  s_barrier
  s_waitcnt lgkmcnt(6)
  v_mfma_f32_16x16x32_bf16 v[136:139], v[56:59], v[100:103], v[136:139]
  ds_read_b128 v[104:107], v5 offset:0
  ds_read_b128 v[32:35], v7 offset:0
  s_waitcnt lgkmcnt(8)
  v_mfma_f32_16x16x32_bf16 v[144:147], v[56:59], v[52:55], v[144:147]
  ds_read_b64_tr_b16 v[36:37], v13 offset:0
  s_waitcnt lgkmcnt(7)
  v_mfma_f32_16x16x32_bf16 v[140:143], v[60:63], v[100:103], v[140:143]
  ds_read_b64_tr_b16 v[38:39], v13 offset:1024
  s_waitcnt lgkmcnt(8)
  v_mfma_f32_16x16x32_bf16 v[148:151], v[60:63], v[52:55], v[148:151]
  ds_read_b64_tr_b16 v[40:41], v14 offset:0
  s_waitcnt lgkmcnt(7)
  v_mfma_f32_16x16x32_bf16 v[152:155], v[64:67], v[100:103], v[152:155]
  ds_read_b64_tr_b16 v[42:43], v14 offset:1024
  ds_read_b64_tr_b16 v[44:45], v13 offset:8192
  s_waitcnt lgkmcnt(9)
  v_mfma_f32_16x16x32_bf16 v[160:163], v[64:67], v[52:55], v[160:163]
  ds_read_b64_tr_b16 v[46:47], v13 offset:9216
  s_waitcnt lgkmcnt(8)
  v_mfma_f32_16x16x32_bf16 v[156:159], v[68:71], v[100:103], v[156:159]
  ds_read_b64_tr_b16 v[48:49], v14 offset:8192
  s_waitcnt lgkmcnt(9)
  v_mfma_f32_16x16x32_bf16 v[164:167], v[68:71], v[52:55], v[164:167]
  ds_read_b64_tr_b16 v[50:51], v14 offset:9216
  s_waitcnt lgkmcnt(6)
  v_mfma_f32_16x16x32_bf16 v[136:139], v[36:39], v[104:107], v[136:139]
  ds_read_b128 v[108:111], v6 offset:0
  ds_read_b128 v[52:55], v8 offset:0
  s_waitcnt lgkmcnt(8)
  v_mfma_f32_16x16x32_bf16 v[144:147], v[36:39], v[32:35], v[144:147]
  ds_read_b64_tr_b16 v[56:57], v13 offset:4096
  s_waitcnt lgkmcnt(7)
  v_mfma_f32_16x16x32_bf16 v[140:143], v[40:43], v[104:107], v[140:143]
  ds_read_b64_tr_b16 v[58:59], v13 offset:5120
  s_waitcnt lgkmcnt(8)
  v_mfma_f32_16x16x32_bf16 v[148:151], v[40:43], v[32:35], v[148:151]
  ds_read_b64_tr_b16 v[60:61], v14 offset:4096
  s_waitcnt lgkmcnt(7)
  v_mfma_f32_16x16x32_bf16 v[152:155], v[44:47], v[104:107], v[152:155]
  ds_read_b64_tr_b16 v[62:63], v14 offset:5120
  ds_read_b64_tr_b16 v[64:65], v13 offset:12288
  s_waitcnt lgkmcnt(9)
  v_mfma_f32_16x16x32_bf16 v[160:163], v[44:47], v[32:35], v[160:163]
  ds_read_b64_tr_b16 v[66:67], v13 offset:13312
  s_waitcnt lgkmcnt(8)
  v_mfma_f32_16x16x32_bf16 v[156:159], v[48:51], v[104:107], v[156:159]
  ds_read_b64_tr_b16 v[68:69], v14 offset:12288
  s_waitcnt lgkmcnt(9)
  v_mfma_f32_16x16x32_bf16 v[164:167], v[48:51], v[32:35], v[164:167]
  ds_read_b64_tr_b16 v[70:71], v14 offset:13312
  s_barrier
  s_waitcnt lgkmcnt(6)
  v_mfma_f32_16x16x32_bf16 v[136:139], v[56:59], v[108:111], v[136:139]
  ds_read_b128 v[112:115], v5 offset:32768
  ds_read_b128 v[32:35], v7 offset:32768
  s_waitcnt lgkmcnt(8)
  v_mfma_f32_16x16x32_bf16 v[144:147], v[56:59], v[52:55], v[144:147]
  ds_read_b64_tr_b16 v[36:37], v13 offset:32768
  s_waitcnt lgkmcnt(7)
  v_mfma_f32_16x16x32_bf16 v[140:143], v[60:63], v[108:111], v[140:143]
  ds_read_b64_tr_b16 v[38:39], v13 offset:33792
  s_waitcnt lgkmcnt(8)
  v_mfma_f32_16x16x32_bf16 v[148:151], v[60:63], v[52:55], v[148:151]
  ds_read_b64_tr_b16 v[40:41], v14 offset:32768
  s_waitcnt lgkmcnt(7)
  v_mfma_f32_16x16x32_bf16 v[152:155], v[64:67], v[108:111], v[152:155]
  ds_read_b64_tr_b16 v[42:43], v14 offset:33792
  ds_read_b64_tr_b16 v[44:45], v13 offset:40960
  s_waitcnt lgkmcnt(9)
  v_mfma_f32_16x16x32_bf16 v[160:163], v[64:67], v[52:55], v[160:163]
  ds_read_b64_tr_b16 v[46:47], v13 offset:41984
  s_waitcnt lgkmcnt(8)
  v_mfma_f32_16x16x32_bf16 v[156:159], v[68:71], v[108:111], v[156:159]
  ds_read_b64_tr_b16 v[48:49], v14 offset:40960
  s_waitcnt lgkmcnt(9)
  v_mfma_f32_16x16x32_bf16 v[164:167], v[68:71], v[52:55], v[164:167]
  ds_read_b64_tr_b16 v[50:51], v14 offset:41984
  s_waitcnt lgkmcnt(6)
  v_mfma_f32_16x16x32_bf16 v[136:139], v[36:39], v[112:115], v[136:139]
  ds_read_b128 v[116:119], v6 offset:32768
  ds_read_b128 v[52:55], v8 offset:32768
  s_waitcnt lgkmcnt(8)
  v_mfma_f32_16x16x32_bf16 v[144:147], v[36:39], v[32:35], v[144:147]
  ds_read_b64_tr_b16 v[56:57], v13 offset:36864
  s_waitcnt lgkmcnt(7)
  v_mfma_f32_16x16x32_bf16 v[140:143], v[40:43], v[112:115], v[140:143]
  ds_read_b64_tr_b16 v[58:59], v13 offset:37888
  s_waitcnt lgkmcnt(8)
  v_mfma_f32_16x16x32_bf16 v[148:151], v[40:43], v[32:35], v[148:151]
  ds_read_b64_tr_b16 v[60:61], v14 offset:36864
  s_waitcnt lgkmcnt(7)
  v_mfma_f32_16x16x32_bf16 v[152:155], v[44:47], v[112:115], v[152:155]
  ds_read_b64_tr_b16 v[62:63], v14 offset:37888
  ds_read_b64_tr_b16 v[64:65], v13 offset:45056
  s_waitcnt lgkmcnt(9)
  v_mfma_f32_16x16x32_bf16 v[160:163], v[44:47], v[32:35], v[160:163]
  ds_read_b64_tr_b16 v[66:67], v13 offset:46080
  s_waitcnt lgkmcnt(8)
  v_mfma_f32_16x16x32_bf16 v[156:159], v[48:51], v[112:115], v[156:159]
  ds_read_b64_tr_b16 v[68:69], v14 offset:45056
  s_waitcnt lgkmcnt(9)
  v_mfma_f32_16x16x32_bf16 v[164:167], v[48:51], v[32:35], v[164:167]
  ds_read_b64_tr_b16 v[70:71], v14 offset:46080
  s_barrier
  s_waitcnt lgkmcnt(6)
  v_mfma_f32_16x16x32_bf16 v[136:139], v[56:59], v[116:119], v[136:139]
  ds_read_b128 v[120:123], v9 offset:0
  ds_read_b128 v[32:35], v11 offset:0
  s_waitcnt lgkmcnt(8)
  v_mfma_f32_16x16x32_bf16 v[144:147], v[56:59], v[52:55], v[144:147]
  ds_read_b64_tr_b16 v[36:37], v15 offset:0
  s_waitcnt lgkmcnt(7)
  v_mfma_f32_16x16x32_bf16 v[140:143], v[60:63], v[116:119], v[140:143]
  ds_read_b64_tr_b16 v[38:39], v15 offset:1024
  s_waitcnt lgkmcnt(8)
  v_mfma_f32_16x16x32_bf16 v[148:151], v[60:63], v[52:55], v[148:151]
  ds_read_b64_tr_b16 v[40:41], v16 offset:0
  s_waitcnt lgkmcnt(7)
  v_mfma_f32_16x16x32_bf16 v[152:155], v[64:67], v[116:119], v[152:155]
  ds_read_b64_tr_b16 v[42:43], v16 offset:1024
  ds_read_b64_tr_b16 v[44:45], v15 offset:8192
  s_waitcnt lgkmcnt(9)
  v_mfma_f32_16x16x32_bf16 v[160:163], v[64:67], v[52:55], v[160:163]
  ds_read_b64_tr_b16 v[46:47], v15 offset:9216
  s_waitcnt lgkmcnt(8)
  v_mfma_f32_16x16x32_bf16 v[156:159], v[68:71], v[116:119], v[156:159]
  ds_read_b64_tr_b16 v[48:49], v16 offset:8192
  s_waitcnt lgkmcnt(9)
  v_mfma_f32_16x16x32_bf16 v[164:167], v[68:71], v[52:55], v[164:167]
  ds_read_b64_tr_b16 v[50:51], v16 offset:9216
  s_waitcnt lgkmcnt(6)
  v_mfma_f32_16x16x32_bf16 v[136:139], v[36:39], v[120:123], v[136:139]
  ds_read_b128 v[124:127], v10 offset:0
  ds_read_b128 v[52:55], v12 offset:0
  s_waitcnt lgkmcnt(8)
  v_mfma_f32_16x16x32_bf16 v[144:147], v[36:39], v[32:35], v[144:147]
  ds_read_b64_tr_b16 v[56:57], v15 offset:4096
  s_waitcnt lgkmcnt(7)
  v_mfma_f32_16x16x32_bf16 v[140:143], v[40:43], v[120:123], v[140:143]
  ds_read_b64_tr_b16 v[58:59], v15 offset:5120
  s_waitcnt lgkmcnt(8)
  v_mfma_f32_16x16x32_bf16 v[148:151], v[40:43], v[32:35], v[148:151]
  ds_read_b64_tr_b16 v[60:61], v16 offset:4096
  s_waitcnt lgkmcnt(7)
  v_mfma_f32_16x16x32_bf16 v[152:155], v[44:47], v[120:123], v[152:155]
  ds_read_b64_tr_b16 v[62:63], v16 offset:5120
  ds_read_b64_tr_b16 v[64:65], v15 offset:12288
  s_waitcnt lgkmcnt(9)
  v_mfma_f32_16x16x32_bf16 v[160:163], v[44:47], v[32:35], v[160:163]
  ds_read_b64_tr_b16 v[66:67], v15 offset:13312
  s_waitcnt lgkmcnt(8)
  v_mfma_f32_16x16x32_bf16 v[156:159], v[48:51], v[120:123], v[156:159]
  ds_read_b64_tr_b16 v[68:69], v16 offset:12288
  s_waitcnt lgkmcnt(9)
  v_mfma_f32_16x16x32_bf16 v[164:167], v[48:51], v[32:35], v[164:167]
  ds_read_b64_tr_b16 v[70:71], v16 offset:13312
  s_barrier
  s_waitcnt lgkmcnt(6)
  v_mfma_f32_16x16x32_bf16 v[136:139], v[56:59], v[124:127], v[136:139]
  ds_read_b128 v[128:131], v9 offset:32768
  ds_read_b128 v[32:35], v11 offset:32768
  s_waitcnt lgkmcnt(8)
  v_mfma_f32_16x16x32_bf16 v[144:147], v[56:59], v[52:55], v[144:147]
  ds_read_b64_tr_b16 v[36:37], v15 offset:32768
  s_waitcnt lgkmcnt(7)
  v_mfma_f32_16x16x32_bf16 v[140:143], v[60:63], v[124:127], v[140:143]
  ds_read_b64_tr_b16 v[38:39], v15 offset:33792
  s_waitcnt lgkmcnt(8)
  v_mfma_f32_16x16x32_bf16 v[148:151], v[60:63], v[52:55], v[148:151]
  ds_read_b64_tr_b16 v[40:41], v16 offset:32768
  s_waitcnt lgkmcnt(7)
  v_mfma_f32_16x16x32_bf16 v[152:155], v[64:67], v[124:127], v[152:155]
  ds_read_b64_tr_b16 v[42:43], v16 offset:33792
  ds_read_b64_tr_b16 v[44:45], v15 offset:40960
  s_waitcnt lgkmcnt(9)
  v_mfma_f32_16x16x32_bf16 v[160:163], v[64:67], v[52:55], v[160:163]
  ds_read_b64_tr_b16 v[46:47], v15 offset:41984
  s_waitcnt lgkmcnt(8)
  v_mfma_f32_16x16x32_bf16 v[156:159], v[68:71], v[124:127], v[156:159]
  ds_read_b64_tr_b16 v[48:49], v16 offset:40960
  s_waitcnt lgkmcnt(9)
  v_mfma_f32_16x16x32_bf16 v[164:167], v[68:71], v[52:55], v[164:167]
  ds_read_b64_tr_b16 v[50:51], v16 offset:41984
  s_waitcnt lgkmcnt(6)
  v_mfma_f32_16x16x32_bf16 v[136:139], v[36:39], v[128:131], v[136:139]
  ds_read_b128 v[132:135], v10 offset:32768
  ds_read_b128 v[52:55], v12 offset:32768
  s_waitcnt lgkmcnt(8)
  v_mfma_f32_16x16x32_bf16 v[144:147], v[36:39], v[32:35], v[144:147]
  ds_read_b64_tr_b16 v[56:57], v15 offset:36864
  s_waitcnt lgkmcnt(7)
  v_mfma_f32_16x16x32_bf16 v[140:143], v[40:43], v[128:131], v[140:143]
  ds_read_b64_tr_b16 v[58:59], v15 offset:37888
  s_waitcnt lgkmcnt(8)
  v_mfma_f32_16x16x32_bf16 v[148:151], v[40:43], v[32:35], v[148:151]
  ds_read_b64_tr_b16 v[60:61], v16 offset:36864
  s_waitcnt lgkmcnt(7)
  v_mfma_f32_16x16x32_bf16 v[152:155], v[44:47], v[128:131], v[152:155]
  ds_read_b64_tr_b16 v[62:63], v16 offset:37888
  ds_read_b64_tr_b16 v[64:65], v15 offset:45056
  s_waitcnt lgkmcnt(9)
  v_mfma_f32_16x16x32_bf16 v[160:163], v[44:47], v[32:35], v[160:163]
  ds_read_b64_tr_b16 v[66:67], v15 offset:46080
  s_waitcnt lgkmcnt(8)
  v_mfma_f32_16x16x32_bf16 v[156:159], v[48:51], v[128:131], v[156:159]
  ds_read_b64_tr_b16 v[68:69], v16 offset:45056
  s_waitcnt lgkmcnt(9)
  v_mfma_f32_16x16x32_bf16 v[164:167], v[48:51], v[32:35], v[164:167]
  ds_read_b64_tr_b16 v[70:71], v16 offset:46080
  s_barrier
  s_waitcnt lgkmcnt(6)
  v_mfma_f32_16x16x32_bf16 v[136:139], v[56:59], v[132:135], v[136:139]
  ds_read_b64_tr_b16 v[36:37], v21 offset:0
  s_waitcnt lgkmcnt(7)
  v_mfma_f32_16x16x32_bf16 v[144:147], v[56:59], v[52:55], v[144:147]
  ds_read_b64_tr_b16 v[38:39], v21 offset:1024
  s_waitcnt lgkmcnt(6)
  v_mfma_f32_16x16x32_bf16 v[140:143], v[60:63], v[132:135], v[140:143]
  ds_read_b64_tr_b16 v[40:41], v22 offset:0
  s_waitcnt lgkmcnt(7)
  v_mfma_f32_16x16x32_bf16 v[148:151], v[60:63], v[52:55], v[148:151]
  ds_read_b64_tr_b16 v[42:43], v22 offset:1024
  s_waitcnt lgkmcnt(6)
  v_mfma_f32_16x16x32_bf16 v[152:155], v[64:67], v[132:135], v[152:155]
  ds_read_b64_tr_b16 v[44:45], v23 offset:0
  s_waitcnt lgkmcnt(7)
  v_mfma_f32_16x16x32_bf16 v[160:163], v[64:67], v[52:55], v[160:163]
  ds_read_b64_tr_b16 v[46:47], v23 offset:1024
  s_waitcnt lgkmcnt(6)
  v_mfma_f32_16x16x32_bf16 v[156:159], v[68:71], v[132:135], v[156:159]
  ds_read_b64_tr_b16 v[48:49], v24 offset:0
  s_waitcnt lgkmcnt(7)
  v_mfma_f32_16x16x32_bf16 v[164:167], v[68:71], v[52:55], v[164:167]
  ds_read_b64_tr_b16 v[50:51], v24 offset:1024
  s_waitcnt lgkmcnt(6)
  v_mfma_f32_16x16x32_bf16 v[32:35], v[36:39], v[72:75], 0
  ds_read_b64_tr_b16 v[56:57], v21 offset:4096
  ds_read_b64_tr_b16 v[58:59], v21 offset:5120
  s_nop 7
  v_pk_mul_f32 v[152:153], v[136:137], v[152:153]
  v_pk_mul_f32 v[154:155], v[138:139], v[154:155]
  v_pk_mul_f32 v[136:137], v[136:137], s[68:69]
  v_pk_mul_f32 v[138:139], v[138:139], s[68:69]
  v_exp_f32 v136, v136
  v_exp_f32 v137, v137
  v_exp_f32 v138, v138
  s_waitcnt lgkmcnt(6)
  v_mfma_f32_16x16x32_bf16 v[52:55], v[40:43], v[72:75], 0
  ds_read_b64_tr_b16 v[60:61], v22 offset:4096
  ds_read_b64_tr_b16 v[62:63], v22 offset:5120
  v_exp_f32 v139, v139
  v_pk_add_f32 v[136:137], v[136:137], s[50:51]
  v_pk_add_f32 v[138:139], v[138:139], s[50:51]
  v_rcp_f32 v136, v136
  v_rcp_f32 v137, v137
  v_rcp_f32 v138, v138
  v_rcp_f32 v139, v139
  v_pk_mul_f32 v[152:153], v[152:153], v[136:137]
  s_waitcnt lgkmcnt(6)
  v_mfma_f32_16x16x32_bf16 v[8:11], v[44:47], v[72:75], 0
  ds_read_b64_tr_b16 v[64:65], v23 offset:4096
  ds_read_b64_tr_b16 v[66:67], v23 offset:5120
  v_pk_mul_f32 v[154:155], v[154:155], v[138:139]
  v_cvt_pk_bf16_f32 v136, v152, v153
  v_cvt_pk_bf16_f32 v137, v154, v155
  v_pk_mul_f32 v[156:157], v[140:141], v[156:157]
  v_pk_mul_f32 v[158:159], v[142:143], v[158:159]
  v_pk_mul_f32 v[140:141], v[140:141], s[68:69]
  v_pk_mul_f32 v[142:143], v[142:143], s[68:69]
  v_exp_f32 v140, v140
  s_waitcnt lgkmcnt(6)
  v_mfma_f32_16x16x32_bf16 v[12:15], v[48:51], v[72:75], 0
  ds_read_b64_tr_b16 v[68:69], v24 offset:4096
  ds_read_b64_tr_b16 v[70:71], v24 offset:5120
  v_exp_f32 v141, v141
  v_exp_f32 v142, v142
  v_exp_f32 v143, v143
  v_pk_add_f32 v[140:141], v[140:141], s[50:51]
  v_pk_add_f32 v[142:143], v[142:143], s[50:51]
  v_rcp_f32 v140, v140
  v_rcp_f32 v141, v141
  v_rcp_f32 v142, v142
  s_waitcnt lgkmcnt(6)
  v_mfma_f32_16x16x32_bf16 v[32:35], v[56:59], v[76:79], v[32:35]
  ds_read_b64_tr_b16 v[36:37], v21 offset:8192
  ds_read_b64_tr_b16 v[38:39], v21 offset:9216
  v_rcp_f32 v143, v143
  v_pk_mul_f32 v[156:157], v[156:157], v[140:141]
  v_pk_mul_f32 v[158:159], v[158:159], v[142:143]
  v_cvt_pk_bf16_f32 v138, v156, v157
  v_cvt_pk_bf16_f32 v139, v158, v159
  s_cmp_eq_u32 s57, 1
  s_cbranch_scc1 L_nopair0
  buffer_store_dwordx4 v[136:139], v28, s[32:35], s53 offen sc1
L_nopair0:
  v_pk_mul_f32 v[160:161], v[144:145], v[160:161]
  v_pk_mul_f32 v[162:163], v[146:147], v[162:163]
  s_waitcnt lgkmcnt(6)
  v_mfma_f32_16x16x32_bf16 v[52:55], v[60:63], v[76:79], v[52:55]
  ds_read_b64_tr_b16 v[40:41], v22 offset:8192
  ds_read_b64_tr_b16 v[42:43], v22 offset:9216
  v_pk_mul_f32 v[144:145], v[144:145], s[68:69]
  v_pk_mul_f32 v[146:147], v[146:147], s[68:69]
  v_exp_f32 v144, v144
  v_exp_f32 v145, v145
  v_exp_f32 v146, v146
  v_exp_f32 v147, v147
  v_pk_add_f32 v[144:145], v[144:145], s[50:51]
  v_pk_add_f32 v[146:147], v[146:147], s[50:51]
  s_waitcnt lgkmcnt(6)
  v_mfma_f32_16x16x32_bf16 v[8:11], v[64:67], v[76:79], v[8:11]
  ds_read_b64_tr_b16 v[44:45], v23 offset:8192
  ds_read_b64_tr_b16 v[46:47], v23 offset:9216
  v_rcp_f32 v144, v144
  v_rcp_f32 v145, v145
  v_rcp_f32 v146, v146
  v_rcp_f32 v147, v147
  v_pk_mul_f32 v[160:161], v[160:161], v[144:145]
  v_pk_mul_f32 v[162:163], v[162:163], v[146:147]
  v_cvt_pk_bf16_f32 v144, v160, v161
  v_cvt_pk_bf16_f32 v145, v162, v163
  s_waitcnt lgkmcnt(6)
  v_mfma_f32_16x16x32_bf16 v[12:15], v[68:71], v[76:79], v[12:15]
  ds_read_b64_tr_b16 v[48:49], v24 offset:8192
  ds_read_b64_tr_b16 v[50:51], v24 offset:9216
  v_pk_mul_f32 v[164:165], v[148:149], v[164:165]
  v_pk_mul_f32 v[166:167], v[150:151], v[166:167]
  v_pk_mul_f32 v[148:149], v[148:149], s[68:69]
  v_pk_mul_f32 v[150:151], v[150:151], s[68:69]
  v_exp_f32 v148, v148
  v_exp_f32 v149, v149
  v_exp_f32 v150, v150
  v_exp_f32 v151, v151
  s_barrier
  s_waitcnt lgkmcnt(6)
  v_mfma_f32_16x16x32_bf16 v[32:35], v[36:39], v[80:83], v[32:35]
  ds_read_b64_tr_b16 v[56:57], v21 offset:12288
  ds_read_b64_tr_b16 v[58:59], v21 offset:13312
  v_pk_add_f32 v[148:149], v[148:149], s[50:51]
  v_pk_add_f32 v[150:151], v[150:151], s[50:51]
  v_rcp_f32 v148, v148
  v_rcp_f32 v149, v149
  v_rcp_f32 v150, v150
  v_rcp_f32 v151, v151
  v_pk_mul_f32 v[164:165], v[164:165], v[148:149]
  v_pk_mul_f32 v[166:167], v[166:167], v[150:151]
  s_waitcnt lgkmcnt(6)
  v_mfma_f32_16x16x32_bf16 v[52:55], v[40:43], v[80:83], v[52:55]
  ds_read_b64_tr_b16 v[60:61], v22 offset:12288
  ds_read_b64_tr_b16 v[62:63], v22 offset:13312
  v_cvt_pk_bf16_f32 v146, v164, v165
  v_cvt_pk_bf16_f32 v147, v166, v167
  s_cmp_eq_u32 s57, 1
  s_cbranch_scc1 L_nopair1
  buffer_store_dwordx4 v[144:147], v28, s[32:35], s54 offen sc1
L_nopair1:
  s_waitcnt lgkmcnt(6)
  v_mfma_f32_16x16x32_bf16 v[8:11], v[44:47], v[80:83], v[8:11]
  ds_read_b64_tr_b16 v[64:65], v23 offset:12288
  ds_read_b64_tr_b16 v[66:67], v23 offset:13312
  s_waitcnt lgkmcnt(6)
  v_mfma_f32_16x16x32_bf16 v[12:15], v[48:51], v[80:83], v[12:15]
  ds_read_b64_tr_b16 v[68:69], v24 offset:12288
  ds_read_b64_tr_b16 v[70:71], v24 offset:13312
  s_waitcnt lgkmcnt(6)
  v_mfma_f32_16x16x32_bf16 v[32:35], v[56:59], v[84:87], v[32:35]
  ds_read_b64_tr_b16 v[36:37], v21 offset:16384
  ds_read_b64_tr_b16 v[38:39], v21 offset:17408
  s_waitcnt lgkmcnt(6)
  v_mfma_f32_16x16x32_bf16 v[52:55], v[60:63], v[84:87], v[52:55]
  ds_read_b64_tr_b16 v[40:41], v22 offset:16384
  ds_read_b64_tr_b16 v[42:43], v22 offset:17408
  s_waitcnt lgkmcnt(6)
  v_mfma_f32_16x16x32_bf16 v[8:11], v[64:67], v[84:87], v[8:11]
  ds_read_b64_tr_b16 v[44:45], v23 offset:16384
  ds_read_b64_tr_b16 v[46:47], v23 offset:17408
  s_waitcnt lgkmcnt(6)
  v_mfma_f32_16x16x32_bf16 v[12:15], v[68:71], v[84:87], v[12:15]
  ds_read_b64_tr_b16 v[48:49], v24 offset:16384
  ds_read_b64_tr_b16 v[50:51], v24 offset:17408
  s_waitcnt lgkmcnt(6)
  v_mfma_f32_16x16x32_bf16 v[32:35], v[36:39], v[88:91], v[32:35]
  ds_read_b64_tr_b16 v[56:57], v21 offset:20480
  ds_read_b64_tr_b16 v[58:59], v21 offset:21504
  s_waitcnt lgkmcnt(6)
  v_mfma_f32_16x16x32_bf16 v[52:55], v[40:43], v[88:91], v[52:55]
  ds_read_b64_tr_b16 v[60:61], v22 offset:20480
  ds_read_b64_tr_b16 v[62:63], v22 offset:21504
  s_waitcnt lgkmcnt(6)
  v_mfma_f32_16x16x32_bf16 v[8:11], v[44:47], v[88:91], v[8:11]
  ds_read_b64_tr_b16 v[64:65], v23 offset:20480
  ds_read_b64_tr_b16 v[66:67], v23 offset:21504
  s_waitcnt lgkmcnt(6)
  v_mfma_f32_16x16x32_bf16 v[12:15], v[48:51], v[88:91], v[12:15]
  ds_read_b64_tr_b16 v[68:69], v24 offset:20480
  ds_read_b64_tr_b16 v[70:71], v24 offset:21504
  s_waitcnt lgkmcnt(6)
  v_mfma_f32_16x16x32_bf16 v[32:35], v[56:59], v[92:95], v[32:35]
  ds_read_b64_tr_b16 v[36:37], v21 offset:24576
  ds_read_b64_tr_b16 v[38:39], v21 offset:25600
  s_waitcnt lgkmcnt(6)
  v_mfma_f32_16x16x32_bf16 v[52:55], v[60:63], v[92:95], v[52:55]
  ds_read_b64_tr_b16 v[40:41], v22 offset:24576
  ds_read_b64_tr_b16 v[42:43], v22 offset:25600
  s_waitcnt lgkmcnt(6)
  v_mfma_f32_16x16x32_bf16 v[8:11], v[64:67], v[92:95], v[8:11]
  ds_read_b64_tr_b16 v[44:45], v23 offset:24576
  ds_read_b64_tr_b16 v[46:47], v23 offset:25600
  s_waitcnt lgkmcnt(6)
  v_mfma_f32_16x16x32_bf16 v[12:15], v[68:71], v[92:95], v[12:15]
  ds_read_b64_tr_b16 v[48:49], v24 offset:24576
  ds_read_b64_tr_b16 v[50:51], v24 offset:25600
  s_waitcnt lgkmcnt(6)
  v_mfma_f32_16x16x32_bf16 v[32:35], v[36:39], v[96:99], v[32:35]
  ds_read_b64_tr_b16 v[56:57], v21 offset:28672
  ds_read_b64_tr_b16 v[58:59], v21 offset:29696
  s_waitcnt lgkmcnt(6)
  v_mfma_f32_16x16x32_bf16 v[52:55], v[40:43], v[96:99], v[52:55]
  ds_read_b64_tr_b16 v[60:61], v22 offset:28672
  ds_read_b64_tr_b16 v[62:63], v22 offset:29696
  s_waitcnt lgkmcnt(6)
  v_mfma_f32_16x16x32_bf16 v[8:11], v[44:47], v[96:99], v[8:11]
  ds_read_b64_tr_b16 v[64:65], v23 offset:28672
  ds_read_b64_tr_b16 v[66:67], v23 offset:29696
  s_waitcnt lgkmcnt(6)
  v_mfma_f32_16x16x32_bf16 v[12:15], v[48:51], v[96:99], v[12:15]
  ds_read_b64_tr_b16 v[68:69], v24 offset:28672
  ds_read_b64_tr_b16 v[70:71], v24 offset:29696
  s_barrier
  s_waitcnt lgkmcnt(6)
  v_mfma_f32_16x16x32_bf16 v[32:35], v[56:59], v[100:103], v[32:35]
  ds_read_b64_tr_b16 v[36:37], v17 offset:0
  ds_read_b64_tr_b16 v[38:39], v17 offset:1024
  s_waitcnt lgkmcnt(6)
  v_mfma_f32_16x16x32_bf16 v[52:55], v[60:63], v[100:103], v[52:55]
  ds_read_b64_tr_b16 v[40:41], v18 offset:0
  ds_read_b64_tr_b16 v[42:43], v18 offset:1024
  s_waitcnt lgkmcnt(6)
  v_mfma_f32_16x16x32_bf16 v[8:11], v[64:67], v[100:103], v[8:11]
  ds_read_b64_tr_b16 v[44:45], v19 offset:0
  ds_read_b64_tr_b16 v[46:47], v19 offset:1024
  s_waitcnt lgkmcnt(6)
  v_mfma_f32_16x16x32_bf16 v[12:15], v[68:71], v[100:103], v[12:15]
  ds_read_b64_tr_b16 v[48:49], v20 offset:0
  ds_read_b64_tr_b16 v[50:51], v20 offset:1024
  s_waitcnt lgkmcnt(6)
  v_mfma_f32_16x16x32_bf16 v[32:35], v[36:39], v[104:107], v[32:35]
  ds_read_b64_tr_b16 v[56:57], v17 offset:4096
  ds_read_b64_tr_b16 v[58:59], v17 offset:5120
  s_waitcnt lgkmcnt(6)
  v_mfma_f32_16x16x32_bf16 v[52:55], v[40:43], v[104:107], v[52:55]
  ds_read_b64_tr_b16 v[60:61], v18 offset:4096
  ds_read_b64_tr_b16 v[62:63], v18 offset:5120
  s_waitcnt lgkmcnt(6)
  v_mfma_f32_16x16x32_bf16 v[8:11], v[44:47], v[104:107], v[8:11]
  ds_read_b64_tr_b16 v[64:65], v19 offset:4096
  ds_read_b64_tr_b16 v[66:67], v19 offset:5120
  s_waitcnt lgkmcnt(6)
  v_mfma_f32_16x16x32_bf16 v[12:15], v[48:51], v[104:107], v[12:15]
  ds_read_b64_tr_b16 v[68:69], v20 offset:4096
  ds_read_b64_tr_b16 v[70:71], v20 offset:5120
  s_barrier
  s_waitcnt lgkmcnt(6)
  v_mfma_f32_16x16x32_bf16 v[32:35], v[56:59], v[108:111], v[32:35]
  ds_read_b64_tr_b16 v[36:37], v17 offset:8192
  ds_read_b64_tr_b16 v[38:39], v17 offset:9216
  s_waitcnt lgkmcnt(6)
  v_mfma_f32_16x16x32_bf16 v[52:55], v[60:63], v[108:111], v[52:55]
  ds_read_b64_tr_b16 v[40:41], v18 offset:8192
  ds_read_b64_tr_b16 v[42:43], v18 offset:9216
  s_waitcnt lgkmcnt(6)
  v_mfma_f32_16x16x32_bf16 v[8:11], v[64:67], v[108:111], v[8:11]
  ds_read_b64_tr_b16 v[44:45], v19 offset:8192
  ds_read_b64_tr_b16 v[46:47], v19 offset:9216
  s_waitcnt lgkmcnt(6)
  v_mfma_f32_16x16x32_bf16 v[12:15], v[68:71], v[108:111], v[12:15]
  ds_read_b64_tr_b16 v[48:49], v20 offset:8192
  ds_read_b64_tr_b16 v[50:51], v20 offset:9216
  s_waitcnt lgkmcnt(6)
  v_mfma_f32_16x16x32_bf16 v[32:35], v[36:39], v[112:115], v[32:35]
  ds_read_b64_tr_b16 v[56:57], v17 offset:12288
  ds_read_b64_tr_b16 v[58:59], v17 offset:13312
  s_waitcnt lgkmcnt(6)
  v_mfma_f32_16x16x32_bf16 v[52:55], v[40:43], v[112:115], v[52:55]
  ds_read_b64_tr_b16 v[60:61], v18 offset:12288
  ds_read_b64_tr_b16 v[62:63], v18 offset:13312
  s_waitcnt lgkmcnt(6)
  v_mfma_f32_16x16x32_bf16 v[8:11], v[44:47], v[112:115], v[8:11]
  ds_read_b64_tr_b16 v[64:65], v19 offset:12288
  ds_read_b64_tr_b16 v[66:67], v19 offset:13312
  s_waitcnt lgkmcnt(6)
  v_mfma_f32_16x16x32_bf16 v[12:15], v[48:51], v[112:115], v[12:15]
  ds_read_b64_tr_b16 v[68:69], v20 offset:12288
  ds_read_b64_tr_b16 v[70:71], v20 offset:13312
  s_waitcnt lgkmcnt(6)
  v_mfma_f32_16x16x32_bf16 v[32:35], v[56:59], v[116:119], v[32:35]
  ds_read_b64_tr_b16 v[36:37], v17 offset:16384
  ds_read_b64_tr_b16 v[38:39], v17 offset:17408
  s_waitcnt lgkmcnt(6)
  v_mfma_f32_16x16x32_bf16 v[52:55], v[60:63], v[116:119], v[52:55]
  ds_read_b64_tr_b16 v[40:41], v18 offset:16384
  ds_read_b64_tr_b16 v[42:43], v18 offset:17408
  s_waitcnt lgkmcnt(6)
  v_mfma_f32_16x16x32_bf16 v[8:11], v[64:67], v[116:119], v[8:11]
  ds_read_b64_tr_b16 v[44:45], v19 offset:16384
  ds_read_b64_tr_b16 v[46:47], v19 offset:17408
  s_waitcnt lgkmcnt(6)
  v_mfma_f32_16x16x32_bf16 v[12:15], v[68:71], v[116:119], v[12:15]
  ds_read_b64_tr_b16 v[48:49], v20 offset:16384
  ds_read_b64_tr_b16 v[50:51], v20 offset:17408
  s_waitcnt vmcnt(0)
  s_barrier
  s_waitcnt lgkmcnt(6)
  v_mfma_f32_16x16x32_bf16 v[32:35], v[36:39], v[120:123], v[32:35]
  ds_read_b64_tr_b16 v[56:57], v17 offset:20480
  ds_read_b64_tr_b16 v[58:59], v17 offset:21504
  s_waitcnt lgkmcnt(6)
  v_mfma_f32_16x16x32_bf16 v[52:55], v[40:43], v[120:123], v[52:55]
  ds_read_b64_tr_b16 v[60:61], v18 offset:20480
  ds_read_b64_tr_b16 v[62:63], v18 offset:21504
  s_waitcnt lgkmcnt(6)
  v_mfma_f32_16x16x32_bf16 v[8:11], v[44:47], v[120:123], v[8:11]
  ds_read_b64_tr_b16 v[64:65], v19 offset:20480
  ds_read_b64_tr_b16 v[66:67], v19 offset:21504
  s_waitcnt lgkmcnt(6)
  v_mfma_f32_16x16x32_bf16 v[12:15], v[48:51], v[120:123], v[12:15]
  ds_read_b64_tr_b16 v[68:69], v20 offset:20480
  ds_read_b64_tr_b16 v[70:71], v20 offset:21504
  s_waitcnt lgkmcnt(6)
  v_mfma_f32_16x16x32_bf16 v[32:35], v[56:59], v[124:127], v[32:35]
  ds_read_b64_tr_b16 v[36:37], v17 offset:24576
  ds_read_b64_tr_b16 v[38:39], v17 offset:25600
  s_waitcnt lgkmcnt(6)
  v_mfma_f32_16x16x32_bf16 v[52:55], v[60:63], v[124:127], v[52:55]
  ds_read_b64_tr_b16 v[40:41], v18 offset:24576
  ds_read_b64_tr_b16 v[42:43], v18 offset:25600
  s_waitcnt lgkmcnt(6)
  v_mfma_f32_16x16x32_bf16 v[8:11], v[64:67], v[124:127], v[8:11]
  ds_read_b64_tr_b16 v[44:45], v19 offset:24576
  ds_read_b64_tr_b16 v[46:47], v19 offset:25600
  s_waitcnt lgkmcnt(6)
  v_mfma_f32_16x16x32_bf16 v[12:15], v[68:71], v[124:127], v[12:15]
  ds_read_b64_tr_b16 v[48:49], v20 offset:24576
  ds_read_b64_tr_b16 v[50:51], v20 offset:25600
  s_waitcnt lgkmcnt(6)
  v_mfma_f32_16x16x32_bf16 v[32:35], v[36:39], v[128:131], v[32:35]
  ds_read_b64_tr_b16 v[56:57], v17 offset:28672
  ds_read_b64_tr_b16 v[58:59], v17 offset:29696
  s_waitcnt lgkmcnt(6)
  v_mfma_f32_16x16x32_bf16 v[52:55], v[40:43], v[128:131], v[52:55]
  ds_read_b64_tr_b16 v[60:61], v18 offset:28672
  ds_read_b64_tr_b16 v[62:63], v18 offset:29696
  s_waitcnt lgkmcnt(6)
  v_mfma_f32_16x16x32_bf16 v[8:11], v[44:47], v[128:131], v[8:11]
  ds_read_b64_tr_b16 v[64:65], v19 offset:28672
  ds_read_b64_tr_b16 v[66:67], v19 offset:29696
  s_waitcnt lgkmcnt(6)
  v_mfma_f32_16x16x32_bf16 v[12:15], v[48:51], v[128:131], v[12:15]
  ds_read_b64_tr_b16 v[68:69], v20 offset:28672
  ds_read_b64_tr_b16 v[70:71], v20 offset:29696
  s_waitcnt lgkmcnt(6)
  v_mfma_f32_16x16x32_bf16 v[32:35], v[56:59], v[132:135], v[32:35]
  s_waitcnt lgkmcnt(4)
  v_mfma_f32_16x16x32_bf16 v[52:55], v[60:63], v[132:135], v[52:55]
  s_waitcnt lgkmcnt(2)
  v_mfma_f32_16x16x32_bf16 v[8:11], v[64:67], v[132:135], v[8:11]
  s_waitcnt lgkmcnt(0)
  v_mfma_f32_16x16x32_bf16 v[12:15], v[68:71], v[132:135], v[12:15]
  s_barrier
  s_nop 5
  v_pk_mul_f32 v[8:9], v[32:33], v[8:9]
  v_pk_mul_f32 v[10:11], v[34:35], v[10:11]
  v_pk_mul_f32 v[32:33], v[32:33], s[68:69]
  v_pk_mul_f32 v[34:35], v[34:35], s[68:69]
  v_exp_f32 v32, v32
  v_exp_f32 v33, v33
  v_exp_f32 v34, v34
  v_exp_f32 v35, v35
  v_pk_add_f32 v[32:33], v[32:33], s[50:51]
  v_pk_add_f32 v[34:35], v[34:35], s[50:51]
  v_rcp_f32 v32, v32
  v_rcp_f32 v33, v33
  v_rcp_f32 v34, v34
  v_rcp_f32 v35, v35
  v_pk_mul_f32 v[8:9], v[8:9], v[32:33]
  v_pk_mul_f32 v[10:11], v[10:11], v[34:35]
  v_cvt_pk_bf16_f32 v32, v8, v9
  v_cvt_pk_bf16_f32 v33, v10, v11
  v_pk_mul_f32 v[12:13], v[52:53], v[12:13]
  v_pk_mul_f32 v[14:15], v[54:55], v[14:15]
  v_pk_mul_f32 v[52:53], v[52:53], s[68:69]
  v_pk_mul_f32 v[54:55], v[54:55], s[68:69]
  v_exp_f32 v52, v52
  v_exp_f32 v53, v53
  v_exp_f32 v54, v54
  v_exp_f32 v55, v55
  v_pk_add_f32 v[52:53], v[52:53], s[50:51]
  v_pk_add_f32 v[54:55], v[54:55], s[50:51]
  v_rcp_f32 v52, v52
  v_rcp_f32 v53, v53
  v_rcp_f32 v54, v54
  v_rcp_f32 v55, v55
  v_pk_mul_f32 v[12:13], v[12:13], v[52:53]
  v_pk_mul_f32 v[14:15], v[14:15], v[54:55]
  v_cvt_pk_bf16_f32 v34, v12, v13
  v_cvt_pk_bf16_f32 v35, v14, v15
  s_cmp_eq_u32 s46, 14
  s_cbranch_scc1 L_join
  buffer_store_dwordx4 v[32:35], v28, s[32:35], s55 offen sc1
L_join:
  s_lshl_b32 s52, s66, 12
  v_lshrrev_b32 v5, 2, v2
  v_lshlrev_b32 v5, 7, v5
  v_and_b32 v6, 3, v2
  v_lshl_add_u32 v5, v6, 3, v5
  v_add_u32 v5, s52, v5
  v_bfe_u32 v6, v2, 3, 2
  v_xor_b32 v7, 0, v6
  v_lshl_add_u32 v16, v7, 5, v5
  v_add_u32 v20, 0x8000, v16
  v_add_u32 v24, 0x18000, v16
  v_xor_b32 v7, 1, v6
  v_lshl_add_u32 v17, v7, 5, v5
  v_add_u32 v21, 0x8000, v17
  v_add_u32 v25, 0x18000, v17
  v_xor_b32 v7, 2, v6
  v_lshl_add_u32 v18, v7, 5, v5
  v_add_u32 v22, 0x8000, v18
  v_add_u32 v26, 0x18000, v18
  v_xor_b32 v7, 3, v6
  v_lshl_add_u32 v19, v7, 5, v5
  v_add_u32 v23, 0x8000, v19
  v_add_u32 v27, 0x18000, v19
  v_add_u32 v29, 44032, v28
  s_lshl_b32 s53, s47, 2
  s_lshl_b32 s54, s67, 1
  s_add_u32 s53, s53, s54
  s_mul_i32 s53, s53, 44032
  s_add_u32 s54, s66, 0
  s_lshr_b32 s55, s54, 1
  s_mul_i32 s55, s55, 3
  s_and_b32 s54, s54, 1
  s_add_u32 s55, s55, s54
  s_lshl_b32 s55, s55, 10
  s_add_u32 s4, s55, s53
  s_add_u32 s54, s66, 4
  s_lshr_b32 s55, s54, 1
  s_mul_i32 s55, s55, 3
  s_and_b32 s54, s54, 1
  s_add_u32 s55, s55, s54
  s_lshl_b32 s55, s55, 10
  s_add_u32 s5, s55, s53
  s_add_u32 s54, s66, 8
  s_lshr_b32 s55, s54, 1
  s_mul_i32 s55, s55, 3
  s_and_b32 s54, s54, 1
  s_add_u32 s55, s55, s54
  s_lshl_b32 s55, s55, 10
  s_add_u32 s6, s55, s53
  s_add_u32 s54, s66, 12
  s_lshr_b32 s55, s54, 1
  s_mul_i32 s55, s55, 3
  s_and_b32 s54, s54, 1
  s_add_u32 s55, s55, s54
  s_lshl_b32 s55, s55, 10
  s_add_u32 s7, s55, s53
  s_add_u32 s54, s66, 16
  s_lshr_b32 s55, s54, 1
  s_mul_i32 s55, s55, 3
  s_and_b32 s54, s54, 1
  s_add_u32 s55, s55, s54
  s_lshl_b32 s55, s55, 10
  s_add_u32 s8, s55, s53
  s_add_u32 s54, s66, 20
  s_lshr_b32 s55, s54, 1
  s_mul_i32 s55, s55, 3
  s_and_b32 s54, s54, 1
  s_add_u32 s55, s55, s54
  s_lshl_b32 s55, s55, 10
  s_add_u32 s9, s55, s53
  s_add_u32 s54, s66, 24
  s_lshr_b32 s55, s54, 1
  s_mul_i32 s55, s55, 3
  s_and_b32 s54, s54, 1
  s_add_u32 s55, s55, s54
  s_lshl_b32 s55, s55, 10
  s_add_u32 s10, s55, s53
  s_add_u32 s54, s66, 28
  s_mul_i32 s55, s54, 3
  s_sub_u32 s55, s55, 85
  s_cmp_eq_u32 s54, 28
  s_cselect_b32 s55, 42, s55
  s_lshl_b32 s55, s55, 10
  s_add_u32 s11, s55, s53
  s_add_u32 s54, s66, 32
  s_mul_i32 s55, s54, 3
  s_sub_u32 s55, s55, 85
  s_lshl_b32 s55, s55, 10
  s_add_u32 s12, s55, s53
  s_add_u32 s54, s66, 36
  s_mul_i32 s55, s54, 3
  s_sub_u32 s55, s55, 85
  s_lshl_b32 s55, s55, 10
  s_add_u32 s13, s55, s53
  s_add_u32 s54, s66, 40
  s_mul_i32 s55, s54, 3
  s_sub_u32 s55, s55, 85
  s_lshl_b32 s55, s55, 10
  s_add_u32 s14, s55, s53
  s_cmp_eq_u32 s66, 3
  s_cselect_b32 s14, 1073741824, s14
  v_mov_b32 v64, 0
  v_mov_b32 v65, 0
  v_mov_b32 v66, 0
  v_mov_b32 v67, 0
  v_mov_b32 v68, 0
  v_mov_b32 v69, 0
  v_mov_b32 v70, 0
  v_mov_b32 v71, 0
  v_mov_b32 v72, 0
  v_mov_b32 v73, 0
  v_mov_b32 v74, 0
  v_mov_b32 v75, 0
  v_mov_b32 v76, 0
  v_mov_b32 v77, 0
  v_mov_b32 v78, 0
  v_mov_b32 v79, 0
  v_mov_b32 v80, 0
  v_mov_b32 v81, 0
  v_mov_b32 v82, 0
  v_mov_b32 v83, 0
  v_mov_b32 v84, 0
  v_mov_b32 v85, 0
  v_mov_b32 v86, 0
  v_mov_b32 v87, 0
  v_mov_b32 v88, 0
  v_mov_b32 v89, 0
  v_mov_b32 v90, 0
  v_mov_b32 v91, 0
  v_mov_b32 v92, 0
  v_mov_b32 v93, 0
  v_mov_b32 v94, 0
  v_mov_b32 v95, 0
  s_waitcnt vmcnt(0)
  s_barrier
  s_barrier
  buffer_load_dwordx4 v[96:99], v28, s[32:35], s4 offen sc1
  buffer_load_dwordx4 v[100:103], v29, s[32:35], s4 offen sc1
  ds_read_b64_tr_b16 v[32:33], v20 offset:0
  ds_read_b64_tr_b16 v[34:35], v20 offset:2048
  ds_read_b64_tr_b16 v[36:37], v21 offset:0
  ds_read_b64_tr_b16 v[38:39], v21 offset:2048
  ds_read_b64_tr_b16 v[40:41], v22 offset:0
  ds_read_b64_tr_b16 v[42:43], v22 offset:2048
  ds_read_b64_tr_b16 v[44:45], v23 offset:0
  ds_read_b64_tr_b16 v[46:47], v23 offset:2048
  buffer_load_dwordx4 v[104:107], v28, s[32:35], s5 offen sc1
  buffer_load_dwordx4 v[108:111], v29, s[32:35], s5 offen sc1
  buffer_load_dwordx4 v[112:115], v28, s[32:35], s6 offen sc1
  buffer_load_dwordx4 v[116:119], v29, s[32:35], s6 offen sc1
  buffer_load_dwordx4 v[120:123], v28, s[32:35], s7 offen sc1
  buffer_load_dwordx4 v[124:127], v29, s[32:35], s7 offen sc1
  buffer_load_dwordx4 v[128:131], v28, s[32:35], s8 offen sc1
  buffer_load_dwordx4 v[132:135], v29, s[32:35], s8 offen sc1
  buffer_load_dwordx4 v[136:139], v28, s[32:35], s9 offen sc1
  buffer_load_dwordx4 v[140:143], v29, s[32:35], s9 offen sc1
  buffer_load_dwordx4 v[144:147], v28, s[32:35], s10 offen sc1
  buffer_load_dwordx4 v[148:151], v29, s[32:35], s10 offen sc1
  s_waitcnt vmcnt(12) lgkmcnt(6)
  v_mfma_f32_16x16x32_bf16 v[64:67], v[32:35], v[96:99], v[64:67]
  ds_read_b64_tr_b16 v[48:49], v20 offset:16384
  v_mfma_f32_16x16x32_bf16 v[80:83], v[32:35], v[100:103], v[80:83]
  ds_read_b64_tr_b16 v[50:51], v20 offset:18432
  s_waitcnt lgkmcnt(6)
  v_mfma_f32_16x16x32_bf16 v[68:71], v[36:39], v[96:99], v[68:71]
  ds_read_b64_tr_b16 v[52:53], v21 offset:16384
  v_mfma_f32_16x16x32_bf16 v[84:87], v[36:39], v[100:103], v[84:87]
  ds_read_b64_tr_b16 v[54:55], v21 offset:18432
  s_waitcnt lgkmcnt(6)
  v_mfma_f32_16x16x32_bf16 v[72:75], v[40:43], v[96:99], v[72:75]
  ds_read_b64_tr_b16 v[56:57], v22 offset:16384
  v_mfma_f32_16x16x32_bf16 v[88:91], v[40:43], v[100:103], v[88:91]
  ds_read_b64_tr_b16 v[58:59], v22 offset:18432
  s_waitcnt lgkmcnt(6)
  v_mfma_f32_16x16x32_bf16 v[76:79], v[44:47], v[96:99], v[76:79]
  ds_read_b64_tr_b16 v[60:61], v23 offset:16384
  v_mfma_f32_16x16x32_bf16 v[92:95], v[44:47], v[100:103], v[92:95]
  ds_read_b64_tr_b16 v[62:63], v23 offset:18432
  s_barrier
  s_waitcnt vmcnt(10) lgkmcnt(6)
  v_mfma_f32_16x16x32_bf16 v[64:67], v[48:51], v[104:107], v[64:67]
  ds_read_b64_tr_b16 v[32:33], v20 offset:32768
  v_mfma_f32_16x16x32_bf16 v[80:83], v[48:51], v[108:111], v[80:83]
  ds_read_b64_tr_b16 v[34:35], v20 offset:34816
  s_waitcnt lgkmcnt(6)
  v_mfma_f32_16x16x32_bf16 v[68:71], v[52:55], v[104:107], v[68:71]
  ds_read_b64_tr_b16 v[36:37], v21 offset:32768
  v_mfma_f32_16x16x32_bf16 v[84:87], v[52:55], v[108:111], v[84:87]
  ds_read_b64_tr_b16 v[38:39], v21 offset:34816
  s_waitcnt lgkmcnt(6)
  v_mfma_f32_16x16x32_bf16 v[72:75], v[56:59], v[104:107], v[72:75]
  ds_read_b64_tr_b16 v[40:41], v22 offset:32768
  v_mfma_f32_16x16x32_bf16 v[88:91], v[56:59], v[108:111], v[88:91]
  ds_read_b64_tr_b16 v[42:43], v22 offset:34816
  s_waitcnt lgkmcnt(6)
  v_mfma_f32_16x16x32_bf16 v[76:79], v[60:63], v[104:107], v[76:79]
  ds_read_b64_tr_b16 v[44:45], v23 offset:32768
  v_mfma_f32_16x16x32_bf16 v[92:95], v[60:63], v[108:111], v[92:95]
  ds_read_b64_tr_b16 v[46:47], v23 offset:34816
  s_waitcnt vmcnt(8) lgkmcnt(6)
  v_mfma_f32_16x16x32_bf16 v[64:67], v[32:35], v[112:115], v[64:67]
  ds_read_b64_tr_b16 v[48:49], v20 offset:49152
  v_mfma_f32_16x16x32_bf16 v[80:83], v[32:35], v[116:119], v[80:83]
  ds_read_b64_tr_b16 v[50:51], v20 offset:51200
  s_waitcnt lgkmcnt(6)
  v_mfma_f32_16x16x32_bf16 v[68:71], v[36:39], v[112:115], v[68:71]
  ds_read_b64_tr_b16 v[52:53], v21 offset:49152
  v_mfma_f32_16x16x32_bf16 v[84:87], v[36:39], v[116:119], v[84:87]
  ds_read_b64_tr_b16 v[54:55], v21 offset:51200
  s_waitcnt lgkmcnt(6)
  v_mfma_f32_16x16x32_bf16 v[72:75], v[40:43], v[112:115], v[72:75]
  ds_read_b64_tr_b16 v[56:57], v22 offset:49152
  v_mfma_f32_16x16x32_bf16 v[88:91], v[40:43], v[116:119], v[88:91]
  ds_read_b64_tr_b16 v[58:59], v22 offset:51200
  s_waitcnt lgkmcnt(6)
  v_mfma_f32_16x16x32_bf16 v[76:79], v[44:47], v[112:115], v[76:79]
  ds_read_b64_tr_b16 v[60:61], v23 offset:49152
  v_mfma_f32_16x16x32_bf16 v[92:95], v[44:47], v[116:119], v[92:95]
  ds_read_b64_tr_b16 v[62:63], v23 offset:51200
  s_waitcnt vmcnt(6) lgkmcnt(6)
  v_mfma_f32_16x16x32_bf16 v[64:67], v[48:51], v[120:123], v[64:67]
  ds_read_b64_tr_b16 v[32:33], v24 offset:0
  v_mfma_f32_16x16x32_bf16 v[80:83], v[48:51], v[124:127], v[80:83]
  ds_read_b64_tr_b16 v[34:35], v24 offset:2048
  s_waitcnt lgkmcnt(6)
  v_mfma_f32_16x16x32_bf16 v[68:71], v[52:55], v[120:123], v[68:71]
  ds_read_b64_tr_b16 v[36:37], v25 offset:0
  v_mfma_f32_16x16x32_bf16 v[84:87], v[52:55], v[124:127], v[84:87]
  ds_read_b64_tr_b16 v[38:39], v25 offset:2048
  s_waitcnt lgkmcnt(6)
  v_mfma_f32_16x16x32_bf16 v[72:75], v[56:59], v[120:123], v[72:75]
  ds_read_b64_tr_b16 v[40:41], v26 offset:0
  v_mfma_f32_16x16x32_bf16 v[88:91], v[56:59], v[124:127], v[88:91]
  ds_read_b64_tr_b16 v[42:43], v26 offset:2048
  s_waitcnt lgkmcnt(6)
  v_mfma_f32_16x16x32_bf16 v[76:79], v[60:63], v[120:123], v[76:79]
  ds_read_b64_tr_b16 v[44:45], v27 offset:0
  v_mfma_f32_16x16x32_bf16 v[92:95], v[60:63], v[124:127], v[92:95]
  ds_read_b64_tr_b16 v[46:47], v27 offset:2048
  s_barrier
  buffer_load_dwordx4 v[152:155], v28, s[32:35], s11 offen sc1
  buffer_load_dwordx4 v[156:159], v29, s[32:35], s11 offen sc1
  buffer_load_dwordx4 v[160:163], v28, s[32:35], s12 offen sc1
  buffer_load_dwordx4 v[164:167], v29, s[32:35], s12 offen sc1
  buffer_load_dwordx4 v[96:99], v28, s[32:35], s13 offen sc1
  buffer_load_dwordx4 v[100:103], v29, s[32:35], s13 offen sc1
  buffer_load_dwordx4 v[104:107], v28, s[32:35], s14 offen sc1
  buffer_load_dwordx4 v[108:111], v29, s[32:35], s14 offen sc1
  s_waitcnt vmcnt(12) lgkmcnt(6)
  v_mfma_f32_16x16x32_bf16 v[64:67], v[32:35], v[128:131], v[64:67]
  ds_read_b64_tr_b16 v[48:49], v24 offset:16384
  v_mfma_f32_16x16x32_bf16 v[80:83], v[32:35], v[132:135], v[80:83]
  ds_read_b64_tr_b16 v[50:51], v24 offset:18432
  s_waitcnt lgkmcnt(6)
  v_mfma_f32_16x16x32_bf16 v[68:71], v[36:39], v[128:131], v[68:71]
  ds_read_b64_tr_b16 v[52:53], v25 offset:16384
  v_mfma_f32_16x16x32_bf16 v[84:87], v[36:39], v[132:135], v[84:87]
  ds_read_b64_tr_b16 v[54:55], v25 offset:18432
  s_waitcnt lgkmcnt(6)
  v_mfma_f32_16x16x32_bf16 v[72:75], v[40:43], v[128:131], v[72:75]
  ds_read_b64_tr_b16 v[56:57], v26 offset:16384
  v_mfma_f32_16x16x32_bf16 v[88:91], v[40:43], v[132:135], v[88:91]
  ds_read_b64_tr_b16 v[58:59], v26 offset:18432
  s_waitcnt lgkmcnt(6)
  v_mfma_f32_16x16x32_bf16 v[76:79], v[44:47], v[128:131], v[76:79]
  ds_read_b64_tr_b16 v[60:61], v27 offset:16384
  v_mfma_f32_16x16x32_bf16 v[92:95], v[44:47], v[132:135], v[92:95]
  ds_read_b64_tr_b16 v[62:63], v27 offset:18432
  s_waitcnt vmcnt(10) lgkmcnt(6)
  v_mfma_f32_16x16x32_bf16 v[64:67], v[48:51], v[136:139], v[64:67]
  ds_read_b64_tr_b16 v[32:33], v24 offset:32768
  v_mfma_f32_16x16x32_bf16 v[80:83], v[48:51], v[140:143], v[80:83]
  ds_read_b64_tr_b16 v[34:35], v24 offset:34816
  s_waitcnt lgkmcnt(6)
  v_mfma_f32_16x16x32_bf16 v[68:71], v[52:55], v[136:139], v[68:71]
  ds_read_b64_tr_b16 v[36:37], v25 offset:32768
  v_mfma_f32_16x16x32_bf16 v[84:87], v[52:55], v[140:143], v[84:87]
  ds_read_b64_tr_b16 v[38:39], v25 offset:34816
  s_waitcnt lgkmcnt(6)
  v_mfma_f32_16x16x32_bf16 v[72:75], v[56:59], v[136:139], v[72:75]
  ds_read_b64_tr_b16 v[40:41], v26 offset:32768
  v_mfma_f32_16x16x32_bf16 v[88:91], v[56:59], v[140:143], v[88:91]
  ds_read_b64_tr_b16 v[42:43], v26 offset:34816
  s_waitcnt lgkmcnt(6)
  v_mfma_f32_16x16x32_bf16 v[76:79], v[60:63], v[136:139], v[76:79]
  ds_read_b64_tr_b16 v[44:45], v27 offset:32768
  v_mfma_f32_16x16x32_bf16 v[92:95], v[60:63], v[140:143], v[92:95]
  ds_read_b64_tr_b16 v[46:47], v27 offset:34816
  s_waitcnt vmcnt(8) lgkmcnt(6)
  v_mfma_f32_16x16x32_bf16 v[64:67], v[32:35], v[144:147], v[64:67]
  ds_read_b64_tr_b16 v[48:49], v24 offset:49152
  v_mfma_f32_16x16x32_bf16 v[80:83], v[32:35], v[148:151], v[80:83]
  ds_read_b64_tr_b16 v[50:51], v24 offset:51200
  s_waitcnt lgkmcnt(6)
  v_mfma_f32_16x16x32_bf16 v[68:71], v[36:39], v[144:147], v[68:71]
  ds_read_b64_tr_b16 v[52:53], v25 offset:49152
  v_mfma_f32_16x16x32_bf16 v[84:87], v[36:39], v[148:151], v[84:87]
  ds_read_b64_tr_b16 v[54:55], v25 offset:51200
  s_waitcnt lgkmcnt(6)
  v_mfma_f32_16x16x32_bf16 v[72:75], v[40:43], v[144:147], v[72:75]
  ds_read_b64_tr_b16 v[56:57], v26 offset:49152
  v_mfma_f32_16x16x32_bf16 v[88:91], v[40:43], v[148:151], v[88:91]
  ds_read_b64_tr_b16 v[58:59], v26 offset:51200
  s_waitcnt lgkmcnt(6)
  v_mfma_f32_16x16x32_bf16 v[76:79], v[44:47], v[144:147], v[76:79]
  ds_read_b64_tr_b16 v[60:61], v27 offset:49152
  v_mfma_f32_16x16x32_bf16 v[92:95], v[44:47], v[148:151], v[92:95]
  ds_read_b64_tr_b16 v[62:63], v27 offset:51200
  s_waitcnt vmcnt(6) lgkmcnt(6)
  v_mfma_f32_16x16x32_bf16 v[64:67], v[48:51], v[152:155], v[64:67]
  ds_read_b64_tr_b16 v[32:33], v16 offset:0
  v_mfma_f32_16x16x32_bf16 v[80:83], v[48:51], v[156:159], v[80:83]
  ds_read_b64_tr_b16 v[34:35], v16 offset:2048
  s_waitcnt lgkmcnt(6)
  v_mfma_f32_16x16x32_bf16 v[68:71], v[52:55], v[152:155], v[68:71]
  ds_read_b64_tr_b16 v[36:37], v17 offset:0
  v_mfma_f32_16x16x32_bf16 v[84:87], v[52:55], v[156:159], v[84:87]
  ds_read_b64_tr_b16 v[38:39], v17 offset:2048
  s_waitcnt lgkmcnt(6)
  v_mfma_f32_16x16x32_bf16 v[72:75], v[56:59], v[152:155], v[72:75]
  ds_read_b64_tr_b16 v[40:41], v18 offset:0
  v_mfma_f32_16x16x32_bf16 v[88:91], v[56:59], v[156:159], v[88:91]
  ds_read_b64_tr_b16 v[42:43], v18 offset:2048
  s_waitcnt lgkmcnt(6)
  v_mfma_f32_16x16x32_bf16 v[76:79], v[60:63], v[152:155], v[76:79]
  ds_read_b64_tr_b16 v[44:45], v19 offset:0
  v_mfma_f32_16x16x32_bf16 v[92:95], v[60:63], v[156:159], v[92:95]
  ds_read_b64_tr_b16 v[46:47], v19 offset:2048
  s_waitcnt lgkmcnt(0)
  s_barrier
  s_waitcnt vmcnt(4) lgkmcnt(6)
  v_mfma_f32_16x16x32_bf16 v[64:67], v[32:35], v[160:163], v[64:67]
  ds_read_b64_tr_b16 v[48:49], v16 offset:16384
  v_mfma_f32_16x16x32_bf16 v[80:83], v[32:35], v[164:167], v[80:83]
  ds_read_b64_tr_b16 v[50:51], v16 offset:18432
  s_waitcnt lgkmcnt(6)
  v_mfma_f32_16x16x32_bf16 v[68:71], v[36:39], v[160:163], v[68:71]
  ds_read_b64_tr_b16 v[52:53], v17 offset:16384
  v_mfma_f32_16x16x32_bf16 v[84:87], v[36:39], v[164:167], v[84:87]
  ds_read_b64_tr_b16 v[54:55], v17 offset:18432
  s_waitcnt lgkmcnt(6)
  v_mfma_f32_16x16x32_bf16 v[72:75], v[40:43], v[160:163], v[72:75]
  ds_read_b64_tr_b16 v[56:57], v18 offset:16384
  v_mfma_f32_16x16x32_bf16 v[88:91], v[40:43], v[164:167], v[88:91]
  ds_read_b64_tr_b16 v[58:59], v18 offset:18432
  s_waitcnt lgkmcnt(6)
  v_mfma_f32_16x16x32_bf16 v[76:79], v[44:47], v[160:163], v[76:79]
  ds_read_b64_tr_b16 v[60:61], v19 offset:16384
  v_mfma_f32_16x16x32_bf16 v[92:95], v[44:47], v[164:167], v[92:95]
  ds_read_b64_tr_b16 v[62:63], v19 offset:18432
  s_waitcnt vmcnt(2) lgkmcnt(6)
  v_mfma_f32_16x16x32_bf16 v[64:67], v[48:51], v[96:99], v[64:67]
  ds_read_b64_tr_b16 v[32:33], v20 offset:0
  v_mfma_f32_16x16x32_bf16 v[80:83], v[48:51], v[100:103], v[80:83]
  ds_read_b64_tr_b16 v[34:35], v20 offset:2048
  s_waitcnt lgkmcnt(6)
  v_mfma_f32_16x16x32_bf16 v[68:71], v[52:55], v[96:99], v[68:71]
  ds_read_b64_tr_b16 v[36:37], v21 offset:0
  v_mfma_f32_16x16x32_bf16 v[84:87], v[52:55], v[100:103], v[84:87]
  ds_read_b64_tr_b16 v[38:39], v21 offset:2048
  s_waitcnt lgkmcnt(6)
  v_mfma_f32_16x16x32_bf16 v[72:75], v[56:59], v[96:99], v[72:75]
  ds_read_b64_tr_b16 v[40:41], v22 offset:0
  v_mfma_f32_16x16x32_bf16 v[88:91], v[56:59], v[100:103], v[88:91]
  ds_read_b64_tr_b16 v[42:43], v22 offset:2048
  s_waitcnt lgkmcnt(6)
  v_mfma_f32_16x16x32_bf16 v[76:79], v[60:63], v[96:99], v[76:79]
  ds_read_b64_tr_b16 v[44:45], v23 offset:0
  v_mfma_f32_16x16x32_bf16 v[92:95], v[60:63], v[100:103], v[92:95]
  ds_read_b64_tr_b16 v[46:47], v23 offset:2048
  s_cmp_eq_u32 s66, 3
  s_cbranch_scc1 L_no10
  s_waitcnt vmcnt(0) lgkmcnt(6)
  v_mfma_f32_16x16x32_bf16 v[64:67], v[32:35], v[104:107], v[64:67]
  v_mfma_f32_16x16x32_bf16 v[80:83], v[32:35], v[108:111], v[80:83]
  s_waitcnt lgkmcnt(4)
  v_mfma_f32_16x16x32_bf16 v[68:71], v[36:39], v[104:107], v[68:71]
  v_mfma_f32_16x16x32_bf16 v[84:87], v[36:39], v[108:111], v[84:87]
  s_waitcnt lgkmcnt(2)
  v_mfma_f32_16x16x32_bf16 v[72:75], v[40:43], v[104:107], v[72:75]
  v_mfma_f32_16x16x32_bf16 v[88:91], v[40:43], v[108:111], v[88:91]
  s_waitcnt lgkmcnt(0)
  v_mfma_f32_16x16x32_bf16 v[76:79], v[44:47], v[104:107], v[76:79]
  v_mfma_f32_16x16x32_bf16 v[92:95], v[44:47], v[108:111], v[92:95]
L_no10:
  s_lshl_b32 s53, s44, 13
  s_add_u32 s53, s53, 49152
  v_add_u32 v5, s53, v28
  s_lshr_b32 s54, s66, 1
  s_lshl_b32 s54, s54, 13
  s_and_b32 s55, s66, 1
  s_lshl_b32 s55, s55, 12
  s_add_u32 s54, s54, s55
  s_lshl_b32 s55, s67, 11
  s_add_u32 s54, s54, s55
  s_add_u32 s54, s54, 49152
  v_add_u32 v6, s54, v28
  s_waitcnt vmcnt(0) lgkmcnt(0)
  s_nop 2
  ds_write_b128 v5, v[64:67] offset:0
  ds_write_b128 v5, v[68:71] offset:1024
  ds_write_b128 v5, v[72:75] offset:2048
  ds_write_b128 v5, v[76:79] offset:3072
  ds_write_b128 v5, v[80:83] offset:4096
  ds_write_b128 v5, v[84:87] offset:5120
  ds_write_b128 v5, v[88:91] offset:6144
  ds_write_b128 v5, v[92:95] offset:7168
  s_lshl_b32 s53, s47, 6
  s_lshl_b32 s54, s66, 4
  s_add_u32 s53, s53, s54
  v_and_b32 v8, 15, v2
  v_add_u32 v8, s53, v8
  v_lshlrev_b32 v8, 10, v8
  s_lshl_b32 s54, s67, 6
  s_add_u32 s54, s54, s49
  v_add_u32 v8, s54, v8
  v_and_b32 v9, 1, v4
  v_lshl_add_u32 v8, v9, 5, v8
  v_lshrrev_b32 v9, 1, v4
  v_lshl_add_u32 v8, v9, 4, v8
  s_waitcnt lgkmcnt(0)
  s_barrier
  ds_read_b128 v[96:99], v6 offset:0
  ds_read_b128 v[100:103], v6 offset:1024
  ds_read_b128 v[104:107], v6 offset:16384
  ds_read_b128 v[108:111], v6 offset:17408
  ds_read_b128 v[112:115], v6 offset:32768
  ds_read_b128 v[116:119], v6 offset:33792
  ds_read_b128 v[120:123], v6 offset:49152
  ds_read_b128 v[124:127], v6 offset:50176
  s_waitcnt lgkmcnt(0)
  v_pk_add_f32 v[96:97], v[96:97], v[104:105]
  v_pk_add_f32 v[112:113], v[112:113], v[120:121]
  v_pk_add_f32 v[96:97], v[96:97], v[112:113]
  v_pk_add_f32 v[98:99], v[98:99], v[106:107]
  v_pk_add_f32 v[114:115], v[114:115], v[122:123]
  v_pk_add_f32 v[98:99], v[98:99], v[114:115]
  v_pk_add_f32 v[100:101], v[100:101], v[108:109]
  v_pk_add_f32 v[116:117], v[116:117], v[124:125]
  v_pk_add_f32 v[100:101], v[100:101], v[116:117]
  v_pk_add_f32 v[102:103], v[102:103], v[110:111]
  v_pk_add_f32 v[118:119], v[118:119], v[126:127]
  v_pk_add_f32 v[102:103], v[102:103], v[118:119]
  v_cvt_pk_bf16_f32 v32, v96, v97
  v_cvt_pk_bf16_f32 v33, v98, v99
  v_cvt_pk_bf16_f32 v34, v100, v101
  v_cvt_pk_bf16_f32 v35, v102, v103
  s_nop 1
  v_permlane16_swap_b32 v32, v34
  v_permlane16_swap_b32 v33, v35
  buffer_store_dwordx4 v[32:35], v8, s[36:39], 0 offen
  s_endpgm
.section .rodata,"a"
.p2align 6
.amdhsa_kernel standalone__swiglu_ffn__prompt_kernel
  .amdhsa_next_free_vgpr 168
  .amdhsa_next_free_sgpr 100
  .amdhsa_accum_offset 168
  .amdhsa_group_segment_fixed_size 0
  .amdhsa_kernarg_size 56
  .amdhsa_user_sgpr_count 2
  .amdhsa_user_sgpr_kernarg_segment_ptr 1
  .amdhsa_system_sgpr_workgroup_id_x 1
.end_amdhsa_kernel
```
